```python
import torch

def _softmax(x, axis=-1):
    return torch.softmax(x, dim=axis)
def _gelu(x):
    return torch.nn.functional.gelu(x, approximate="tanh")
def _silu(x):
    return torch.nn.functional.silu(x)
def _sigmoid(x):
    return torch.sigmoid(x)
def _layernorm(x, axis=-1, eps=1e-5):
    m = x.mean(dim=axis, keepdim=True)
    v = x.var(dim=axis, keepdim=True, unbiased=False)
    return (x - m) / torch.sqrt(v + eps)
def _scatter_add(tgt, idx, src, axis=0):
    return tgt.clone().index_add_(axis, idx, src)
def _segment_sum(src, seg, n):
    out = torch.zeros((n,) + src.shape[1:], dtype=src.dtype)
    return out.index_add_(0, seg, src)
def _pad(x, pw):
    flat = tuple(v for pair in reversed(pw) for v in pair)
    return torch.nn.functional.pad(x, flat)

kernel_name = 'standalone__paged_block_table_kv_radixattention__sampling'

def setup_inputs():

    _w = (lambda a: (lambda t: t.to(torch.bfloat16) if t.is_floating_point() else t)(torch.as_tensor(a)))
    B, H, Hkv, Dh = 8, 32, 32, 192
    Lk = 4096
    bs = 16
    nb = max(2, Lk // bs)
    P = max(1, nb // 2)
    n_phys = P + B * (nb - P)
    shared = torch.arange(P, dtype=torch.int64)
    priv = P + torch.arange(B * (nb - P), dtype=torch.int64).reshape(B, nb - P)
    bt = torch.cat([torch.tile(shared[None, :], (B, 1)), priv], dim=1)
    ctx = nb * bs - (torch.arange(1, B + 1, dtype=torch.int64) * 2654435761) % max(1, (nb * bs - P * bs) // 2)
    return {
        "q": _w((lambda *s: torch.randn(*s, dtype=torch.bfloat16) * 0.8)(B, H, Dh)),
        "k_cache": _w((lambda *s: torch.randn(*s, dtype=torch.bfloat16) * 0.8)(n_phys, bs, Hkv, Dh)),
        "v_cache": _w((lambda *s: torch.randn(*s, dtype=torch.bfloat16) * 0.05)(n_phys, bs, Hkv, Dh)),
        "block_table": _w(bt.to(torch.int64)),
        "ctx_lens": _w(torch.as_tensor(ctx).to(torch.int64)),
    }

def reference(q, k_cache, v_cache, block_table, ctx_lens):
    B, H, Dh = q.shape
    n_phys, bs, Hkv, _ = k_cache.shape
    nb = block_table.shape[1]
    Lk = nb * bs
    rep = H // Hkv
    k = k_cache[block_table].reshape(B, Lk, Hkv, Dh)
    v = v_cache[block_table].reshape(B, Lk, Hkv, Dh)
    k = (lambda x, n, axis: torch.repeat_interleave(x, n, dim=axis))(k, rep, axis=2)
    v = (lambda x, n, axis: torch.repeat_interleave(x, n, dim=axis))(v, rep, axis=2)
    scores = torch.einsum("bhd,bkhd->bhk", q, k) * (Dh ** -0.5)
    pos = torch.arange(Lk)
    valid = pos[None, :] < ctx_lens[:, None]
    scores = torch.where(valid[:, None, :], scores, -1e9)
    p = _softmax(scores, axis=-1)
    return torch.einsum("bhk,bkhd->bhd", p, v)
```

```asm
; @launch grid=(256,1,1) block=(256,1,1) lds=73728
.amdgcn_target "amdgcn-amd-amdhsa--gfx950"
.text
.globl standalone__paged_block_table_kv_radixattention__sampling_kernel
.p2align 8
.type standalone__paged_block_table_kv_radixattention__sampling_kernel,@function
standalone__paged_block_table_kv_radixattention__sampling_kernel:
    s_cmp_ge_u32 s2, 256
    s_cbranch_scc1 L_end
    s_load_dwordx16 s[4:19], s[0:1], 0
    s_getpc_b64 s[28:29]
    s_and_b32 s29, s29, 0xffff
    s_mov_b32 s30, L_end-standalone__paged_block_table_kv_radixattention__sampling_kernel-64
    s_mov_b32 s31, 0x20000
    s_lshr_b32 s49, s2, 3
    s_lshl_b32 s49, s49, 9
    v_lshlrev_b32 v2, 1, v0
    v_and_b32 v2, 0x180, v2
    buffer_load_dword v31, v2, s[28:31], s49 offen
    v_and_b32 v1, 63, v0
    v_lshrrev_b32 v2, 6, v0
    v_and_b32 v3, 15, v0
    v_readfirstlane_b32 s36, v2
    v_lshrrev_b32 v4, 4, v1
    v_lshrrev_b32 v5, 1, v3
    v_mul_u32_u24 v5, 12288, v5
    v_and_b32 v2, 1, v0
    v_lshl_add_u32 v5, v2, 6, v5
    v_lshl_add_u32 v5, v4, 4, v5
    v_and_b32 v2, 7, v0
    v_mul_u32_u24 v40, 12288, v2
    v_lshlrev_b32 v41, 2, v2
    v_lshlrev_b32_e64 v13, v2, 1
    v_and_b32 v2, 8, v0
    v_lshl_add_u32 v40, v2, 3, v40
    v_lshl_add_u32 v40, v4, 4, v40
    v_lshlrev_b32 v42, 2, v0
    s_and_b32 s38, s2, 15
    s_lshr_b32 s51, s2, 4
    s_mul_i32 s42, s51, 768
    s_lshr_b32 s53, s38, 1
    s_and_b32 s47, s38, 1
    s_mul_i32 s47, s47, 384
    s_add_u32 s47, s47, s42
    s_and_b32 s41, s36, 1
    s_mul_i32 s49, s41, 384
    s_add_u32 s42, s42, s49
    s_lshr_b32 s49, s36, 1
    s_mul_i32 s49, s49, 98304
    s_add_u32 s37, s42, s49
    s_add_u32 s54, s47, s49
    s_lshl_b32 s48, s53, 10
    s_mov_b32 s30, 8192
    s_mov_b32 s34, 32
    s_mov_b32 s35, 0x20000
    s_mov_b32 s26, 98304
    s_mov_b32 s27, 0x20000
    s_mov_b32 s22, 226492416
    s_mov_b32 s23, 0x20000
    s_mov_b32 s43, 0xc4dfbad5
    s_cmp_lt_u32 s53, 4
    s_cselect_b32 s43, s43, 0xd8b3cee9
    s_and_b32 s49, s53, 3
    s_lshl_b32 s49, s49, 3
    s_lshr_b32 s43, s43, s49
    s_and_b32 s43, s43, 0xff
    s_lshl_b32 s49, s53, 7
    s_add_u32 s43, s43, s49
    s_add_u32 s43, s43, s41
    s_mul_i32 s94, s43, 196608
    s_add_u32 s94, s94, s54
    s_add_u32 s95, s94, 393216
    s_add_u32 s96, s95, 393216
    s_add_u32 s97, s96, 393216
    s_add_u32 s98, s97, 393216
    s_add_u32 s99, s98, 393216
    s_add_u32 s100, s99, 393216
    s_add_u32 s101, s100, 393216
    s_movk_i32 s49, 4096
    s_waitcnt lgkmcnt(0)
    s_mov_b32 s32, s12
    s_and_b32 s33, s13, 0xffff
    s_mov_b32 s28, s10
    s_and_b32 s29, s11, 0xffff
    buffer_load_dword v12, v41, s[32:35], 0 offen
    buffer_load_dword v32, v42, s[28:31], s48 offen
    buffer_load_dword v56, v42, s[28:31], 0 offen offset:0
    buffer_load_dword v57, v42, s[28:31], 0 offen offset:1024
    buffer_load_dword v58, v42, s[28:31], 0 offen offset:2048
    buffer_load_dword v59, v42, s[28:31], 0 offen offset:3072
    buffer_load_dword v60, v42, s[28:31], s49 offen offset:0
    buffer_load_dword v61, v42, s[28:31], s49 offen offset:1024
    buffer_load_dword v62, v42, s[28:31], s49 offen offset:2048
    buffer_load_dword v63, v42, s[28:31], s49 offen offset:3072
    s_mov_b32 s20, s6
    s_and_b32 s21, s7, 0xffff
    buffer_load_dwordx4 a[0:3], v5, s[20:23], s94 offen offset:0 nt
    buffer_load_dwordx4 a[4:7], v5, s[20:23], s94 offen offset:128 nt
    buffer_load_dwordx4 a[8:11], v5, s[20:23], s94 offen offset:256 nt
    buffer_load_dwordx4 a[12:15], v5, s[20:23], s95 offen offset:0 nt
    buffer_load_dwordx4 a[16:19], v5, s[20:23], s95 offen offset:128 nt
    buffer_load_dwordx4 a[20:23], v5, s[20:23], s95 offen offset:256 nt
    s_mov_b32 s24, s4
    s_and_b32 s25, s5, 0xffff
    s_mov_b32 s32, s6
    s_and_b32 s33, s7, 0xffff
    v_cmp_eq_u32 vcc, 0, v2
    v_mul_u32_u24 v6, 24576, v4
    v_lshl_add_u32 v7, v3, 3, v6
    v_add_u32 v7, 256, v7
    v_lshl_add_u32 v6, v3, 4, v6
    v_add_u32 v8, 12288, v6
    v_add_u32 v9, 12288, v7
    v_mov_b32 v3, 0
    s_mov_b32 s44, 0x05040100
    v_cndmask_b32_e64 v14, 0, -1, vcc
    v_cndmask_b32_e64 v15, -1, 0, vcc
    s_mov_b32 s45, 0x07060302
    s_mov_b32 s46, 0x3dd53b95
    ds_write_b32 v42, v3 offset:1024
    v_mov_b32 v224, 0
    v_mov_b32 v225, 0
    v_mov_b32 v226, 0
    v_mov_b32 v227, 0
    v_mov_b32 v228, 0
    v_mov_b32 v229, 0
    v_mov_b32 v230, 0
    v_mov_b32 v231, 0
    v_mov_b32 v128, 0
    v_mov_b32 v129, 0
    v_mov_b32 v130, 0
    v_mov_b32 v131, 0
    v_mov_b32 v132, 0
    v_mov_b32 v133, 0
    v_mov_b32 v134, 0
    v_mov_b32 v135, 0
    v_mov_b32 v136, 0
    v_mov_b32 v137, 0
    v_mov_b32 v138, 0
    v_mov_b32 v139, 0
    v_mov_b32 v140, 0
    v_mov_b32 v141, 0
    v_mov_b32 v142, 0
    v_mov_b32 v143, 0
    v_mov_b32 v144, 0
    v_mov_b32 v145, 0
    v_mov_b32 v146, 0
    v_mov_b32 v147, 0
    v_mov_b32 v148, 0
    v_mov_b32 v149, 0
    v_mov_b32 v150, 0
    v_mov_b32 v151, 0
    v_mov_b32 v152, 0
    v_mov_b32 v153, 0
    v_mov_b32 v154, 0
    v_mov_b32 v155, 0
    v_mov_b32 v156, 0
    v_mov_b32 v157, 0
    v_mov_b32 v158, 0
    v_mov_b32 v159, 0
    v_mov_b32 v160, 0
    v_mov_b32 v161, 0
    v_mov_b32 v162, 0
    v_mov_b32 v163, 0
    v_mov_b32 v164, 0
    v_mov_b32 v165, 0
    v_mov_b32 v166, 0
    v_mov_b32 v167, 0
    v_mov_b32 v168, 0
    v_mov_b32 v169, 0
    v_mov_b32 v170, 0
    v_mov_b32 v171, 0
    v_mov_b32 v172, 0
    v_mov_b32 v173, 0
    v_mov_b32 v174, 0
    v_mov_b32 v175, 0
    v_mov_b32 v19, 0xf149f2ca
    v_mov_b32 v28, 0xf149f2ca
    v_mov_b32 v20, 0
    s_mul_i32 s49, s36, 13312
    v_lshl_add_u32 v26, v1, 4, s49
    v_mov_b32 v16, 0xff800000
    v_mov_b32 v3, 4096
    s_lshr_b32 s49, s36, 1
    s_lshl_b32 s49, s49, 3
    v_lshl_add_u32 v4, v4, 1, s49
    v_mov_b32 v43, 1151
    s_waitcnt vmcnt(15)
    v_cmp_gt_i32 vcc, 1, v12
    v_min_i32 v12, 4096, v12
    s_nop 0
    v_cndmask_b32 v3, v12, v3, vcc
    v_cndmask_b32_e64 v11, 0, -1, vcc
    v_sub_u32 v12, v3, v4
    v_readlane_b32 s50, v3, s53
    v_add_u32 v3, -241, v3
    v_ashrrev_i32 v3, 4, v3
    v_max_i32 v3, 0, v3
    s_nop 0
    v_readlane_b32 s56, v3, 0
    v_readlane_b32 s57, v3, 1
    v_readlane_b32 s58, v3, 2
    v_readlane_b32 s59, v3, 3
    v_readlane_b32 s60, v3, 4
    v_readlane_b32 s61, v3, 5
    v_readlane_b32 s62, v3, 6
    v_readlane_b32 s63, v3, 7
    v_readlane_b32 s3, v3, s53
    s_waitcnt vmcnt(6)
    v_min_u32 v32, v43, v32
    ds_write_b32 v42, v32 offset:2560
    buffer_load_dwordx4 a[60:63], v40, s[24:27], s47 offen offset:0
    buffer_load_dwordx4 a[64:67], v40, s[24:27], s47 offen offset:128
    buffer_load_dwordx4 a[68:71], v40, s[24:27], s47 offen offset:256
    buffer_load_dwordx4 a[48:51], v40, s[24:27], s42 offen offset:0
    buffer_load_dwordx4 a[52:55], v40, s[24:27], s42 offen offset:128
    buffer_load_dwordx4 a[56:59], v40, s[24:27], s42 offen offset:256
    s_mov_b32 s24, s8
    s_and_b32 s25, s9, 0xffff
    s_mov_b32 s26, 226492416
    v_cmp_gt_i32 s[64:65], s56, v0
    v_cmp_gt_i32 s[66:67], s57, v0
    v_cmp_gt_i32 s[68:69], s58, v0
    v_cmp_gt_i32 s[70:71], s59, v0
    v_cmp_gt_i32 s[72:73], s60, v0
    v_cmp_gt_i32 s[74:75], s61, v0
    v_cmp_gt_i32 s[76:77], s62, v0
    v_cmp_gt_i32 s[78:79], s63, v0
    v_min_u32 v56, v43, v56
    v_min_u32 v57, v43, v57
    v_min_u32 v58, v43, v58
    v_min_u32 v59, v43, v59
    v_min_u32 v60, v43, v60
    v_min_u32 v61, v43, v61
    v_min_u32 v62, v43, v62
    v_min_u32 v63, v43, v63
    v_mov_b32 v2, 2048
    v_cndmask_b32_e64 v56, v2, v56, s[64:65]
    v_mov_b32 v2, 2049
    v_cndmask_b32_e64 v57, v2, v57, s[66:67]
    v_mov_b32 v2, 2050
    v_cndmask_b32_e64 v58, v2, v58, s[68:69]
    v_mov_b32 v2, 2051
    v_cndmask_b32_e64 v59, v2, v59, s[70:71]
    v_mov_b32 v2, 2052
    v_cndmask_b32_e64 v60, v2, v60, s[72:73]
    v_mov_b32 v2, 2053
    v_cndmask_b32_e64 v61, v2, v61, s[74:75]
    v_mov_b32 v2, 2054
    v_cndmask_b32_e64 v62, v2, v62, s[76:77]
    v_mov_b32 v2, 2055
    v_cndmask_b32_e64 v63, v2, v63, s[78:79]
    v_cmp_eq_u32 s[80:81], v56, v63
    v_cmp_eq_u32 s[82:83], v56, v62
    v_cmp_eq_u32 s[84:85], v56, v61
    v_cmp_eq_u32 s[86:87], v56, v60
    v_cmp_eq_u32 s[88:89], v56, v59
    v_cmp_eq_u32 s[90:91], v56, v58
    v_cmp_eq_u32 s[92:93], v56, v57
    v_addc_co_u32 v224, vcc, v224, v224, s[80:81]
    s_andn2_b64 s[78:79], s[78:79], s[80:81]
    buffer_load_dwordx4 a[24:27], v5, s[20:23], s96 offen offset:0 nt
    v_addc_co_u32 v224, vcc, v224, v224, s[82:83]
    s_andn2_b64 s[76:77], s[76:77], s[82:83]
    v_addc_co_u32 v224, vcc, v224, v224, s[84:85]
    s_andn2_b64 s[74:75], s[74:75], s[84:85]
    v_addc_co_u32 v224, vcc, v224, v224, s[86:87]
    s_andn2_b64 s[72:73], s[72:73], s[86:87]
    v_addc_co_u32 v224, vcc, v224, v224, s[88:89]
    s_andn2_b64 s[70:71], s[70:71], s[88:89]
    v_addc_co_u32 v224, vcc, v224, v224, s[90:91]
    s_andn2_b64 s[68:69], s[68:69], s[90:91]
    v_addc_co_u32 v224, vcc, v224, v224, s[92:93]
    s_andn2_b64 s[66:67], s[66:67], s[92:93]
    v_cmp_eq_u32 s[80:81], v57, v63
    v_cmp_eq_u32 s[82:83], v57, v62
    v_cmp_eq_u32 s[84:85], v57, v61
    v_cmp_eq_u32 s[86:87], v57, v60
    v_cmp_eq_u32 s[88:89], v57, v59
    v_cmp_eq_u32 s[90:91], v57, v58
    v_addc_co_u32 v225, vcc, v225, v225, s[80:81]
    s_andn2_b64 s[78:79], s[78:79], s[80:81]
    v_addc_co_u32 v225, vcc, v225, v225, s[82:83]
    s_andn2_b64 s[76:77], s[76:77], s[82:83]
    v_addc_co_u32 v225, vcc, v225, v225, s[84:85]
    s_andn2_b64 s[74:75], s[74:75], s[84:85]
    v_addc_co_u32 v225, vcc, v225, v225, s[86:87]
    s_andn2_b64 s[72:73], s[72:73], s[86:87]
    v_addc_co_u32 v225, vcc, v225, v225, s[88:89]
    s_andn2_b64 s[70:71], s[70:71], s[88:89]
    v_addc_co_u32 v225, vcc, v225, v225, s[90:91]
    s_andn2_b64 s[68:69], s[68:69], s[90:91]
    v_cmp_eq_u32 s[80:81], v58, v63
    v_cmp_eq_u32 s[82:83], v58, v62
    v_cmp_eq_u32 s[84:85], v58, v61
    v_cmp_eq_u32 s[86:87], v58, v60
    v_cmp_eq_u32 s[88:89], v58, v59
    v_addc_co_u32 v226, vcc, v226, v226, s[80:81]
    s_andn2_b64 s[78:79], s[78:79], s[80:81]
    v_addc_co_u32 v226, vcc, v226, v226, s[82:83]
    s_andn2_b64 s[76:77], s[76:77], s[82:83]
    v_addc_co_u32 v226, vcc, v226, v226, s[84:85]
    s_andn2_b64 s[74:75], s[74:75], s[84:85]
    buffer_load_dwordx4 a[28:31], v5, s[20:23], s96 offen offset:128 nt
    v_addc_co_u32 v226, vcc, v226, v226, s[86:87]
    s_andn2_b64 s[72:73], s[72:73], s[86:87]
    v_addc_co_u32 v226, vcc, v226, v226, s[88:89]
    s_andn2_b64 s[70:71], s[70:71], s[88:89]
    v_cmp_eq_u32 s[80:81], v59, v63
    v_cmp_eq_u32 s[82:83], v59, v62
    v_cmp_eq_u32 s[84:85], v59, v61
    v_cmp_eq_u32 s[86:87], v59, v60
    v_addc_co_u32 v227, vcc, v227, v227, s[80:81]
    s_andn2_b64 s[78:79], s[78:79], s[80:81]
    v_addc_co_u32 v227, vcc, v227, v227, s[82:83]
    s_andn2_b64 s[76:77], s[76:77], s[82:83]
    v_addc_co_u32 v227, vcc, v227, v227, s[84:85]
    s_andn2_b64 s[74:75], s[74:75], s[84:85]
    v_addc_co_u32 v227, vcc, v227, v227, s[86:87]
    s_andn2_b64 s[72:73], s[72:73], s[86:87]
    v_cmp_eq_u32 s[80:81], v60, v63
    v_cmp_eq_u32 s[82:83], v60, v62
    v_cmp_eq_u32 s[84:85], v60, v61
    v_addc_co_u32 v228, vcc, v228, v228, s[80:81]
    s_andn2_b64 s[78:79], s[78:79], s[80:81]
    v_addc_co_u32 v228, vcc, v228, v228, s[82:83]
    s_andn2_b64 s[76:77], s[76:77], s[82:83]
    v_addc_co_u32 v228, vcc, v228, v228, s[84:85]
    s_andn2_b64 s[74:75], s[74:75], s[84:85]
    v_cmp_eq_u32 s[80:81], v61, v63
    v_cmp_eq_u32 s[82:83], v61, v62
    s_nop 1
    v_addc_co_u32 v229, vcc, v229, v229, s[80:81]
    s_andn2_b64 s[78:79], s[78:79], s[80:81]
    v_addc_co_u32 v229, vcc, v229, v229, s[82:83]
    s_andn2_b64 s[76:77], s[76:77], s[82:83]
    v_cmp_eq_u32 s[80:81], v62, v63
    s_nop 1
    v_addc_co_u32 v230, vcc, v230, v230, s[80:81]
    s_andn2_b64 s[78:79], s[78:79], s[80:81]
    s_movk_i32 s48, 683
    s_mov_b32 s39, 0
    v_cmp_gt_u32 s[80:81], s48, v56
    v_cmp_gt_u32 s[82:83], s48, v57
    v_cmp_gt_u32 s[84:85], s48, v58
    buffer_load_dwordx4 a[32:35], v5, s[20:23], s96 offen offset:256 nt
    v_cmp_gt_u32 s[86:87], s48, v59
    s_bcnt1_i32_b64 s56, s[64:65]
    v_writelane_b32 v2, s56, 0
    s_and_b64 s[80:81], s[80:81], s[64:65]
    s_bcnt1_i32_b64 s49, s[80:81]
    s_add_u32 s39, s39, s49
    s_bcnt1_i32_b64 s57, s[66:67]
    v_writelane_b32 v2, s57, 1
    s_and_b64 s[82:83], s[82:83], s[66:67]
    s_bcnt1_i32_b64 s49, s[82:83]
    s_add_u32 s39, s39, s49
    s_bcnt1_i32_b64 s58, s[68:69]
    v_writelane_b32 v2, s58, 2
    s_and_b64 s[84:85], s[84:85], s[68:69]
    s_bcnt1_i32_b64 s49, s[84:85]
    s_add_u32 s39, s39, s49
    s_bcnt1_i32_b64 s59, s[70:71]
    v_writelane_b32 v2, s59, 3
    s_and_b64 s[86:87], s[86:87], s[70:71]
    s_bcnt1_i32_b64 s49, s[86:87]
    s_add_u32 s39, s39, s49
    v_cmp_gt_u32 s[80:81], s48, v60
    v_cmp_gt_u32 s[82:83], s48, v61
    v_cmp_gt_u32 s[84:85], s48, v62
    v_cmp_gt_u32 s[86:87], s48, v63
    s_bcnt1_i32_b64 s60, s[72:73]
    v_writelane_b32 v2, s60, 4
    s_and_b64 s[80:81], s[80:81], s[72:73]
    s_bcnt1_i32_b64 s49, s[80:81]
    s_add_u32 s39, s39, s49
    s_bcnt1_i32_b64 s61, s[74:75]
    v_writelane_b32 v2, s61, 5
    s_and_b64 s[82:83], s[82:83], s[74:75]
    s_bcnt1_i32_b64 s49, s[82:83]
    s_add_u32 s39, s39, s49
    s_bcnt1_i32_b64 s62, s[76:77]
    v_writelane_b32 v2, s62, 6
    s_and_b64 s[84:85], s[84:85], s[76:77]
    s_bcnt1_i32_b64 s49, s[84:85]
    s_add_u32 s39, s39, s49
    s_bcnt1_i32_b64 s63, s[78:79]
    buffer_load_dwordx4 a[36:39], v5, s[20:23], s97 offen offset:0 nt
    v_writelane_b32 v2, s63, 7
    s_and_b64 s[86:87], s[86:87], s[78:79]
    s_bcnt1_i32_b64 s49, s[86:87]
    s_add_u32 s39, s39, s49
    v_writelane_b32 v2, s39, 8
    v_lshlrev_b32 v3, 4, v1
    s_lshl_b32 s49, s36, 2
    v_add_u32 v3, s49, v3
    s_mov_b64 exec, 0x1ff
    ds_write_b32 v3, v2
    s_mov_b64 exec, -1
    s_add_u32 s3, s3, s41
    v_lshlrev_b32 v2, 1, v1
    v_add_u32 v22, s43, v2
    v_add_u32 v21, s3, v2
    v_min_u32 v2, 255, v21
    v_lshlrev_b32 v29, 2, v2
    v_lshl_or_b32 v224, v224, 1, 1
    v_lshlrev_b32 v224, 24, v224
    v_or_b32 v224, v224, v56
    v_lshl_or_b32 v225, v225, 1, 1
    v_lshlrev_b32 v225, 25, v225
    v_or_b32 v225, v225, v57
    v_lshl_or_b32 v226, v226, 1, 1
    v_lshlrev_b32 v226, 26, v226
    v_or_b32 v226, v226, v58
    v_lshl_or_b32 v227, v227, 1, 1
    v_lshlrev_b32 v227, 27, v227
    v_or_b32 v227, v227, v59
    v_lshl_or_b32 v228, v228, 1, 1
    v_lshlrev_b32 v228, 28, v228
    v_or_b32 v228, v228, v60
    v_lshl_or_b32 v229, v229, 1, 1
    v_lshlrev_b32 v229, 29, v229
    v_or_b32 v229, v229, v61
    v_lshl_or_b32 v230, v230, 1, 1
    v_lshlrev_b32 v230, 30, v230
    v_or_b32 v230, v230, v62
    v_lshl_or_b32 v231, v231, 1, 1
    v_lshlrev_b32 v231, 31, v231
    v_or_b32 v231, v231, v63
    v_lshlrev_b32 v3, 2, v1
    s_waitcnt lgkmcnt(0)
    s_barrier
    ds_read_b32 v30, v29 offset:2560
    ds_read_b32 v2, v3
    v_mbcnt_lo_u32_b32 v232, s64, 0
    v_mbcnt_hi_u32_b32 v232, s65, v232
    v_mbcnt_lo_u32_b32 v233, s66, 0
    v_mbcnt_hi_u32_b32 v233, s67, v233
    v_mbcnt_lo_u32_b32 v234, s68, 0
    v_mbcnt_hi_u32_b32 v234, s69, v234
    v_mbcnt_lo_u32_b32 v235, s70, 0
    v_mbcnt_hi_u32_b32 v235, s71, v235
    v_mbcnt_lo_u32_b32 v236, s72, 0
    v_mbcnt_hi_u32_b32 v236, s73, v236
    v_mbcnt_lo_u32_b32 v237, s74, 0
    v_mbcnt_hi_u32_b32 v237, s75, v237
    v_mbcnt_lo_u32_b32 v238, s76, 0
    v_mbcnt_hi_u32_b32 v238, s77, v238
    v_mbcnt_lo_u32_b32 v239, s78, 0
    v_mbcnt_hi_u32_b32 v239, s79, v239
    s_waitcnt lgkmcnt(0)
    v_cmp_ne_u32 vcc, v30, v22
    s_and_b32 s49, vcc_lo, 0xff
    s_cbranch_scc1 L_miss
L_hit:
    s_lshl_b32 s49, s3, 4
    s_sub_i32 s49, s50, s49
    s_sub_i32 s49, s49, 224
    s_max_i32 s49, s49, 0
    s_min_i32 s49, s49, 16
    s_mul_i32 s49, s49, 12288
    s_add_u32 s49, s49, s101
    s_sub_u32 s49, s49, s54
    s_min_u32 s34, s49, 226492416
    s_mov_b32 s42, 0x41800000
    v_mov_b32 v4, v2
    v_add_u32_dpp v2, v2, v2 row_shr:1 row_mask:0xf bank_mask:0xf bound_ctrl:0
    s_nop 1
    v_add_u32_dpp v2, v2, v2 row_shr:2 row_mask:0xf bank_mask:0xf bound_ctrl:0
    s_nop 1
    v_add_u32_dpp v2, v2, v2 row_shr:4 row_mask:0xf bank_mask:0xf bound_ctrl:0
    s_nop 1
    v_add_u32_dpp v2, v2, v2 row_shr:8 row_mask:0xf bank_mask:0xf bound_ctrl:0
    s_nop 1
    v_add_u32_dpp v2, v2, v2 row_bcast:15 row_mask:0xa bank_mask:0xf
    s_nop 0
    v_readlane_b32 s52, v2, 31
    v_readlane_b32 s55, v2, 35
    v_sub_u32 v2, v2, v4
    s_sub_u32 s52, s52, s55
    s_mul_i32 s39, s55, s38
    s_add_u32 s40, s39, s55
    s_lshr_b32 s39, s39, 4
    s_lshr_b32 s40, s40, 4
    s_sub_u32 s40, s40, s39
    s_xor_b32 s49, s38, 1
    s_mul_i32 s49, s52, s49
    s_add_u32 s48, s49, s52
    s_lshr_b32 s49, s49, 4
    s_lshr_b32 s48, s48, 4
    s_sub_u32 s48, s48, s49
    v_cvt_f32_u32 v72, s55
    v_cvt_f32_u32 v73, s52
    v_mov_b32 v74, s39
    s_add_u32 s49, s49, s55
    buffer_load_dwordx4 a[40:43], v5, s[20:23], s97 offen offset:128 nt
    s_sub_u32 s49, s49, s40
    v_mov_b32 v75, s49
    v_rcp_f32 v72, v72
    v_rcp_f32 v73, v73
    v_mov_b32 v76, s55
    v_mov_b32 v77, 0x41780000
    s_add_u32 s40, s40, s48
    s_add_u32 s41, s36, 0
    v_readlane_b32 s56, v2, s41
    s_add_u32 s41, s36, 4
    v_readlane_b32 s57, v2, s41
    s_add_u32 s41, s36, 8
    v_readlane_b32 s58, v2, s41
    s_add_u32 s41, s36, 12
    v_readlane_b32 s59, v2, s41
    s_add_u32 s41, s36, 16
    v_readlane_b32 s60, v2, s41
    s_add_u32 s41, s36, 20
    v_readlane_b32 s61, v2, s41
    s_add_u32 s41, s36, 24
    v_readlane_b32 s62, v2, s41
    s_add_u32 s41, s36, 28
    v_readlane_b32 s63, v2, s41
    s_nop 0
    v_add_u32 v232, s56, v232
    v_add_u32 v233, s57, v233
    v_add_u32 v234, s58, v234
    v_add_u32 v235, s59, v235
    v_add_u32 v236, s60, v236
    v_add_u32 v237, s61, v237
    buffer_load_dwordx4 a[44:47], v5, s[20:23], s97 offen offset:256 nt
    v_add_u32 v238, s62, v238
    v_add_u32 v239, s63, v239
    v_cmp_le_u32 vcc, s55, v232
    v_lshrrev_b32 v33, 24, v224
    s_nop 0
    v_cndmask_b32_e64 v4, 0, v76, vcc
    v_cndmask_b32 v29, v72, v73, vcc
    v_cndmask_b32 v2, v74, v75, vcc
    v_cndmask_b32_e64 v30, 0, 1, vcc
    v_sub_u32 v4, v232, v4
    v_sub_u32 v2, v232, v2
    v_cvt_f32_u32 v4, v4
    v_lshlrev_b32 v2, 2, v2
    v_fma_f32 v4, v4, s42, v77
    v_mul_f32 v4, v4, v29
    v_cvt_u32_f32 v4, v4
    v_xor_b32 v4, v4, v30
    v_cmp_eq_u32 vcc, s38, v4
    v_lshlrev_b32 v4, 2, v4
    s_mov_b64 exec, s[64:65]
    ds_or_b32 v4, v33 offset:1024
    s_and_b64 exec, exec, vcc
    ds_write_b32 v2, v224 offset:256
    s_mov_b64 exec, -1
    v_cmp_le_u32 vcc, s55, v233
    v_lshrrev_b32 v33, 24, v225
    s_nop 0
    v_cndmask_b32_e64 v4, 0, v76, vcc
    v_cndmask_b32 v29, v72, v73, vcc
    v_cndmask_b32 v2, v74, v75, vcc
    v_cndmask_b32_e64 v30, 0, 1, vcc
    v_sub_u32 v4, v233, v4
    v_sub_u32 v2, v233, v2
    v_cvt_f32_u32 v4, v4
    buffer_load_dwordx4 a[72:75], v5, s[20:23], s98 offen offset:0 nt
    v_lshlrev_b32 v2, 2, v2
    v_fma_f32 v4, v4, s42, v77
    v_mul_f32 v4, v4, v29
    v_cvt_u32_f32 v4, v4
    v_xor_b32 v4, v4, v30
    v_cmp_eq_u32 vcc, s38, v4
    v_lshlrev_b32 v4, 2, v4
    s_mov_b64 exec, s[66:67]
    ds_or_b32 v4, v33 offset:1024
    s_and_b64 exec, exec, vcc
    ds_write_b32 v2, v225 offset:256
    s_mov_b64 exec, -1
    v_cmp_le_u32 vcc, s55, v234
    v_lshrrev_b32 v33, 24, v226
    s_nop 0
    v_cndmask_b32_e64 v4, 0, v76, vcc
    v_cndmask_b32 v29, v72, v73, vcc
    v_cndmask_b32 v2, v74, v75, vcc
    v_cndmask_b32_e64 v30, 0, 1, vcc
    v_sub_u32 v4, v234, v4
    v_sub_u32 v2, v234, v2
    v_cvt_f32_u32 v4, v4
    v_lshlrev_b32 v2, 2, v2
    v_fma_f32 v4, v4, s42, v77
    v_mul_f32 v4, v4, v29
    v_cvt_u32_f32 v4, v4
    v_xor_b32 v4, v4, v30
    v_cmp_eq_u32 vcc, s38, v4
    v_lshlrev_b32 v4, 2, v4
    s_mov_b64 exec, s[68:69]
    ds_or_b32 v4, v33 offset:1024
    s_and_b64 exec, exec, vcc
    ds_write_b32 v2, v226 offset:256
    s_mov_b64 exec, -1
    v_cmp_le_u32 vcc, s55, v235
    v_lshrrev_b32 v33, 24, v227
    s_nop 0
    v_cndmask_b32_e64 v4, 0, v76, vcc
    v_cndmask_b32 v29, v72, v73, vcc
    buffer_load_dwordx4 a[76:79], v5, s[20:23], s98 offen offset:128 nt
    v_cndmask_b32 v2, v74, v75, vcc
    v_cndmask_b32_e64 v30, 0, 1, vcc
    v_sub_u32 v4, v235, v4
    v_sub_u32 v2, v235, v2
    v_cvt_f32_u32 v4, v4
    v_lshlrev_b32 v2, 2, v2
    v_fma_f32 v4, v4, s42, v77
    v_mul_f32 v4, v4, v29
    v_cvt_u32_f32 v4, v4
    v_xor_b32 v4, v4, v30
    v_cmp_eq_u32 vcc, s38, v4
    v_lshlrev_b32 v4, 2, v4
    s_mov_b64 exec, s[70:71]
    ds_or_b32 v4, v33 offset:1024
    s_and_b64 exec, exec, vcc
    ds_write_b32 v2, v227 offset:256
    s_mov_b64 exec, -1
    v_cmp_le_u32 vcc, s55, v236
    v_lshrrev_b32 v33, 24, v228
    s_nop 0
    v_cndmask_b32_e64 v4, 0, v76, vcc
    v_cndmask_b32 v29, v72, v73, vcc
    v_cndmask_b32 v2, v74, v75, vcc
    v_cndmask_b32_e64 v30, 0, 1, vcc
    v_sub_u32 v4, v236, v4
    v_sub_u32 v2, v236, v2
    v_cvt_f32_u32 v4, v4
    v_lshlrev_b32 v2, 2, v2
    v_fma_f32 v4, v4, s42, v77
    v_mul_f32 v4, v4, v29
    v_cvt_u32_f32 v4, v4
    v_xor_b32 v4, v4, v30
    v_cmp_eq_u32 vcc, s38, v4
    v_lshlrev_b32 v4, 2, v4
    buffer_load_dwordx4 a[80:83], v5, s[20:23], s98 offen offset:256 nt
    s_mov_b64 exec, s[72:73]
    ds_or_b32 v4, v33 offset:1024
    s_and_b64 exec, exec, vcc
    ds_write_b32 v2, v228 offset:256
    s_mov_b64 exec, -1
    v_cmp_le_u32 vcc, s55, v237
    v_lshrrev_b32 v33, 24, v229
    s_nop 0
    v_cndmask_b32_e64 v4, 0, v76, vcc
    v_cndmask_b32 v29, v72, v73, vcc
    v_cndmask_b32 v2, v74, v75, vcc
    v_cndmask_b32_e64 v30, 0, 1, vcc
    v_sub_u32 v4, v237, v4
    v_sub_u32 v2, v237, v2
    v_cvt_f32_u32 v4, v4
    v_lshlrev_b32 v2, 2, v2
    v_fma_f32 v4, v4, s42, v77
    v_mul_f32 v4, v4, v29
    v_cvt_u32_f32 v4, v4
    v_xor_b32 v4, v4, v30
    v_cmp_eq_u32 vcc, s38, v4
    v_lshlrev_b32 v4, 2, v4
    s_mov_b64 exec, s[74:75]
    ds_or_b32 v4, v33 offset:1024
    s_and_b64 exec, exec, vcc
    ds_write_b32 v2, v229 offset:256
    s_mov_b64 exec, -1
    v_cmp_le_u32 vcc, s55, v238
    v_lshrrev_b32 v33, 24, v230
    s_nop 0
    v_cndmask_b32_e64 v4, 0, v76, vcc
    v_cndmask_b32 v29, v72, v73, vcc
    v_cndmask_b32 v2, v74, v75, vcc
    v_cndmask_b32_e64 v30, 0, 1, vcc
    v_sub_u32 v4, v238, v4
    v_sub_u32 v2, v238, v2
    v_cvt_f32_u32 v4, v4
    v_lshlrev_b32 v2, 2, v2
    buffer_load_dwordx4 a[84:87], v5, s[20:23], s99 offen offset:0 nt
    v_fma_f32 v4, v4, s42, v77
    v_mul_f32 v4, v4, v29
    v_cvt_u32_f32 v4, v4
    v_xor_b32 v4, v4, v30
    v_cmp_eq_u32 vcc, s38, v4
    v_lshlrev_b32 v4, 2, v4
    s_mov_b64 exec, s[76:77]
    ds_or_b32 v4, v33 offset:1024
    s_and_b64 exec, exec, vcc
    ds_write_b32 v2, v230 offset:256
    s_mov_b64 exec, -1
    s_waitcnt lgkmcnt(6)
    v_cmp_le_u32 vcc, s55, v239
    v_lshrrev_b32 v33, 24, v231
    s_nop 0
    v_cndmask_b32_e64 v4, 0, v76, vcc
    v_cndmask_b32 v29, v72, v73, vcc
    v_cndmask_b32 v2, v74, v75, vcc
    v_cndmask_b32_e64 v30, 0, 1, vcc
    v_sub_u32 v4, v239, v4
    v_sub_u32 v2, v239, v2
    v_cvt_f32_u32 v4, v4
    v_lshlrev_b32 v2, 2, v2
    v_fma_f32 v4, v4, s42, v77
    v_mul_f32 v4, v4, v29
    v_cvt_u32_f32 v4, v4
    v_xor_b32 v4, v4, v30
    v_cmp_eq_u32 vcc, s38, v4
    v_lshlrev_b32 v4, 2, v4
    s_mov_b64 exec, s[78:79]
    ds_or_b32 v4, v33 offset:1024
    s_and_b64 exec, exec, vcc
    ds_write_b32 v2, v231 offset:256
    s_mov_b64 exec, -1
    s_sub_i32 s62, s40, 52
    s_max_i32 s62, s62, 0
    s_mov_b32 s63, s34
    v_cmp_ne_u32 s[60:61], 0, v11
    s_waitcnt lgkmcnt(0)
    s_barrier
    ds_read_b32 v10, v3 offset:1024
    s_cmp_lg_u32 s62, 0
    s_cbranch_scc1 L_slow0
L_fast:
    v_add_u32 v2, s62, v1
    v_lshlrev_b32 v4, 2, v2
    ds_read_b32 v17, v4 offset:256
    v_mov_b32 v27, v19
    s_waitcnt vmcnt(5)
    buffer_load_dwordx4 a[88:91], v5, s[20:23], s99 offen offset:128 nt
    v_add_u32 v2, s62, v1
    v_cmp_gt_u32 vcc, s40, v2
    v_and_b32 v4, 3, v1
    v_lshlrev_b32 v4, 3, v4
    s_mov_b32 s49, 196608
    v_mov_b32 v2, 226492416
    s_waitcnt lgkmcnt(0)
    v_lshrrev_b32 v18, 24, v17
    v_and_b32 v17, 0x7ff, v17
    v_cndmask_b32_e64 v18, 0, v18, vcc
    v_mul_lo_u32 v17, v17, s49
    v_lshlrev_b32 v18, v4, v18
    v_add_u32 v17, s37, v17
    v_cndmask_b32 v17, v2, v17, vcc
    v_or_b32_dpp v18, v18, v18 quad_perm:[1,0,3,2] row_mask:0xf bank_mask:0xf
    s_nop 1
    v_or_b32_dpp v18, v18, v18 quad_perm:[2,3,0,1] row_mask:0xf bank_mask:0xf
    s_nop 0
    s_sub_u32 s40, s40, s62
    v_readlane_b32 s43, v10, s38
    v_lshrrev_b32 v10, s53, v10
    v_and_b32 v10, 1, v10
    v_cmp_eq_u32 s[72:73], 1, v10
    s_and_b64 s[72:73], s[72:73], 0xffff
    s_waitcnt vmcnt(5)
    buffer_load_dwordx4 a[92:95], v5, s[20:23], s99 offen offset:256 nt
    s_add_u32 s49, s3, 0
    s_lshl_b32 s49, s49, 4
    v_and_b32 v2, 32, v15
    v_add_u32 v2, s49, v2
    s_lshl_b32 s48, 1, s53
    v_cmp_eq_u32 vcc, s48, v13
    v_sub_u32 v21, v12, v2
    s_nop 0
    v_cndmask_b32_e64 v21, 0, v21, vcc
    v_add_u32 v2, 0xffffffc0, v21
    v_cmp_lt_i32 s[80:81], 0, v21
    v_cmp_lt_i32 s[82:83], 1, v21
    v_cmp_lt_i32 s[84:85], 0, v2
    v_cmp_lt_i32 s[86:87], 1, v2
    v_mfma_f32_16x16x32_bf16 v[56:59], a[0:3], a[60:63], 0
    v_mfma_f32_16x16x32_bf16 v[56:59], a[4:7], a[64:67], v[56:59]
    v_mfma_f32_16x16x32_bf16 v[56:59], a[8:11], a[68:71], v[56:59]
    v_mfma_f32_16x16x32_bf16 v[64:67], a[12:15], a[60:63], 0
    v_mfma_f32_16x16x32_bf16 v[64:67], a[16:19], a[64:67], v[64:67]
    v_mfma_f32_16x16x32_bf16 v[64:67], a[20:23], a[68:71], v[64:67]
    s_waitcnt vmcnt(5)
    buffer_load_dwordx4 a[96:99], v5, s[20:23], s100 offen offset:0 nt
    v_mfma_f32_16x16x32_bf16 v[60:63], a[24:27], a[60:63], 0
    v_mfma_f32_16x16x32_bf16 v[60:63], a[28:31], a[64:67], v[60:63]
    v_mfma_f32_16x16x32_bf16 v[60:63], a[32:35], a[68:71], v[60:63]
    v_mfma_f32_16x16x32_bf16 v[68:71], a[36:39], a[60:63], 0
    v_mfma_f32_16x16x32_bf16 v[68:71], a[40:43], a[64:67], v[68:71]
    v_mfma_f32_16x16x32_bf16 v[68:71], a[44:47], a[68:71], v[68:71]
    s_waitcnt vmcnt(5)
    buffer_load_dwordx4 a[100:103], v5, s[20:23], s100 offen offset:128 nt
    s_waitcnt vmcnt(5)
    buffer_load_dwordx4 a[104:107], v5, s[20:23], s100 offen offset:256 nt
    s_waitcnt vmcnt(5)
    buffer_load_dwordx4 a[108:111], v5, s[32:35], s101 offen offset:0 nt
    s_waitcnt vmcnt(5)
    buffer_load_dwordx4 a[112:115], v5, s[32:35], s101 offen offset:128 nt
    s_waitcnt vmcnt(5)
    buffer_load_dwordx4 a[116:119], v5, s[32:35], s101 offen offset:256 nt
    s_mov_b32 s41, 0
    v_readlane_b32 s42, v18, s41
    v_readlane_b32 s56, v17, s41
    s_add_u32 s49, s41, 1
    v_readlane_b32 s57, v17, s49
    s_add_u32 s49, s41, 2
    v_readlane_b32 s58, v17, s49
    s_add_u32 s49, s41, 3
    v_readlane_b32 s59, v17, s49
    s_nop 0
    s_waitcnt vmcnt(5)
    buffer_load_dwordx4 a[0:3], v5, s[20:23], s56 offen offset:0 nt
    s_nop 7
    v_add_f32_dpp v120, v57, v56 row_ror:8 row_mask:0xf bank_mask:0x3
    v_add_f32_dpp v120, v64, v65 row_ror:8 row_mask:0xf bank_mask:0xc
    v_add_f32_dpp v121, v59, v58 row_ror:8 row_mask:0xf bank_mask:0x3
    v_add_f32_dpp v121, v66, v67 row_ror:8 row_mask:0xf bank_mask:0xc
    v_add_f32_dpp v122, v61, v60 row_ror:8 row_mask:0xf bank_mask:0x3
    v_add_f32_dpp v122, v68, v69 row_ror:8 row_mask:0xf bank_mask:0xc
    v_add_f32_dpp v123, v63, v62 row_ror:8 row_mask:0xf bank_mask:0x3
    v_add_f32_dpp v123, v70, v71 row_ror:8 row_mask:0xf bank_mask:0xc
    v_mul_f32 v120, s46, v120
    v_mul_f32 v121, s46, v121
    v_mul_f32 v122, s46, v122
    v_mul_f32 v123, s46, v123
    v_cndmask_b32_e64 v120, v120, 0, s[60:61]
    v_cndmask_b32_e64 v121, v121, 0, s[60:61]
    v_cndmask_b32_e64 v122, v122, 0, s[60:61]
    v_cndmask_b32_e64 v123, v123, 0, s[60:61]
    v_cndmask_b32_e64 v120, v16, v120, s[80:81]
    v_cndmask_b32_e64 v121, v16, v121, s[82:83]
    v_cndmask_b32_e64 v122, v16, v122, s[84:85]
    v_cndmask_b32_e64 v123, v16, v123, s[86:87]
    v_max3_f32 v28, v120, v121, v28
    v_max3_f32 v28, v122, v123, v28
    s_waitcnt vmcnt(5)
    buffer_load_dwordx4 a[4:7], v5, s[20:23], s56 offen offset:128 nt
    s_add_u32 s49, s3, 8
    s_lshl_b32 s49, s49, 4
    v_and_b32 v2, 32, v15
    v_add_u32 v2, s49, v2
    s_lshl_b32 s48, 1, s53
    v_cmp_eq_u32 vcc, s48, v13
    v_sub_u32 v21, v12, v2
    s_nop 0
    v_cndmask_b32_e64 v21, 0, v21, vcc
    v_add_u32 v2, 0xffffffc0, v21
    v_cmp_lt_i32 s[80:81], 0, v21
    v_cmp_lt_i32 s[82:83], 1, v21
    v_cmp_lt_i32 s[84:85], 0, v2
    v_cmp_lt_i32 s[86:87], 1, v2
    v_mfma_f32_16x16x32_bf16 v[56:59], a[72:75], a[60:63], 0
    v_mfma_f32_16x16x32_bf16 v[56:59], a[76:79], a[64:67], v[56:59]
    v_mfma_f32_16x16x32_bf16 v[56:59], a[80:83], a[68:71], v[56:59]
    v_mfma_f32_16x16x32_bf16 v[64:67], a[84:87], a[60:63], 0
    v_mfma_f32_16x16x32_bf16 v[64:67], a[88:91], a[64:67], v[64:67]
    v_mfma_f32_16x16x32_bf16 v[64:67], a[92:95], a[68:71], v[64:67]
    s_waitcnt vmcnt(5)
    buffer_load_dwordx4 a[8:11], v5, s[20:23], s56 offen offset:256 nt
    v_mfma_f32_16x16x32_bf16 v[60:63], a[96:99], a[60:63], 0
    v_mfma_f32_16x16x32_bf16 v[60:63], a[100:103], a[64:67], v[60:63]
    v_mfma_f32_16x16x32_bf16 v[60:63], a[104:107], a[68:71], v[60:63]
    s_waitcnt vmcnt(5)
    buffer_load_dwordx4 a[12:15], v5, s[20:23], s57 offen offset:0 nt
    s_mov_b32 s32, s18
    s_and_b32 s33, s19, 0xffff
    s_mov_b32 s34, 4195328
    s_mov_b32 s28, s14
    s_and_b32 s29, s15, 0xffff
    s_mov_b32 s30, 98304
    s_or_b32 s49, s36, s2
    s_cmp_lg_u32 s49, 0
    s_cbranch_scc1 L_nn1
    s_mov_b32 s49, 4194304
    s_mov_b32 s90, 0x01010101
    s_atomic_add s90, s[18:19], s49 glc
L_nn1:
    s_waitcnt vmcnt(5)
    buffer_load_dwordx4 a[16:19], v5, s[20:23], s57 offen offset:128 nt
    s_waitcnt vmcnt(5)
    buffer_load_dwordx4 a[20:23], v5, s[20:23], s57 offen offset:256 nt
    v_mfma_f32_16x16x32_bf16 v[68:71], a[108:111], a[60:63], 0
    v_mfma_f32_16x16x32_bf16 v[68:71], a[112:115], a[64:67], v[68:71]
    v_mfma_f32_16x16x32_bf16 v[68:71], a[116:119], a[68:71], v[68:71]
    s_waitcnt vmcnt(5)
    buffer_load_dwordx4 a[24:27], v5, s[20:23], s58 offen offset:0 nt
    s_nop 7
    v_add_f32_dpp v124, v57, v56 row_ror:8 row_mask:0xf bank_mask:0x3
    v_add_f32_dpp v124, v64, v65 row_ror:8 row_mask:0xf bank_mask:0xc
    v_add_f32_dpp v125, v59, v58 row_ror:8 row_mask:0xf bank_mask:0x3
    v_add_f32_dpp v125, v66, v67 row_ror:8 row_mask:0xf bank_mask:0xc
    v_add_f32_dpp v126, v61, v60 row_ror:8 row_mask:0xf bank_mask:0x3
    v_add_f32_dpp v126, v68, v69 row_ror:8 row_mask:0xf bank_mask:0xc
    v_add_f32_dpp v127, v63, v62 row_ror:8 row_mask:0xf bank_mask:0x3
    v_add_f32_dpp v127, v70, v71 row_ror:8 row_mask:0xf bank_mask:0xc
    v_mul_f32 v124, s46, v124
    v_mul_f32 v125, s46, v125
    s_waitcnt vmcnt(5)
    buffer_load_dwordx4 a[28:31], v5, s[20:23], s58 offen offset:128 nt
    v_mul_f32 v126, s46, v126
    v_mul_f32 v127, s46, v127
    v_cndmask_b32_e64 v124, v124, 0, s[60:61]
    v_cndmask_b32_e64 v125, v125, 0, s[60:61]
    v_cndmask_b32_e64 v126, v126, 0, s[60:61]
    v_cndmask_b32_e64 v127, v127, 0, s[60:61]
    v_cndmask_b32_e64 v124, v16, v124, s[80:81]
    v_cndmask_b32_e64 v125, v16, v125, s[82:83]
    v_cndmask_b32_e64 v126, v16, v126, s[84:85]
    v_cndmask_b32_e64 v127, v16, v127, s[86:87]
    v_max3_f32 v28, v124, v125, v28
    v_max3_f32 v28, v126, v127, v28
    s_waitcnt vmcnt(5)
    buffer_load_dwordx4 a[32:35], v5, s[20:23], s58 offen offset:256 nt
    v_mfma_f32_16x16x32_bf16 v[56:59], a[0:3], a[48:51], 0
    v_mfma_f32_16x16x32_bf16 v[56:59], a[4:7], a[52:55], v[56:59]
    v_mfma_f32_16x16x32_bf16 v[56:59], a[8:11], a[56:59], v[56:59]
    s_waitcnt vmcnt(5)
    buffer_load_dwordx4 a[36:39], v5, s[20:23], s59 offen offset:0 nt
    s_waitcnt vmcnt(5)
    buffer_load_dwordx4 a[40:43], v5, s[20:23], s59 offen offset:128 nt
    s_waitcnt vmcnt(5)
    buffer_load_dwordx4 a[44:47], v5, s[20:23], s59 offen offset:256 nt
    s_mov_b32 s41, 4
    s_cmp_ge_u32 s41, s40
    s_cbranch_scc1 L_kdone
L_kloop:
    s_mov_b32 s92, s42
    v_readlane_b32 s42, v18, s41
    v_readlane_b32 s56, v17, s41
    s_add_u32 s49, s41, 1
    v_readlane_b32 s57, v17, s49
    s_add_u32 s49, s41, 2
    v_readlane_b32 s58, v17, s49
    s_add_u32 s49, s41, 3
    v_readlane_b32 s59, v17, s49
    s_nop 0
    s_waitcnt vmcnt(5)
    buffer_load_dwordx4 a[0:3], v5, s[20:23], s56 offen offset:0 nt
    s_pack_ll_b32_b16 s80, s92, s92
    s_pack_hh_b32_b16 s84, s92, s92
    s_mov_b32 s81, s80
    s_mov_b32 s85, s84
    v_mfma_f32_16x16x32_bf16 v[64:67], a[12:15], a[48:51], 0
    v_mfma_f32_16x16x32_bf16 v[64:67], a[16:19], a[52:55], v[64:67]
    v_mfma_f32_16x16x32_bf16 v[64:67], a[20:23], a[56:59], v[64:67]
    s_waitcnt vmcnt(5)
    buffer_load_dwordx4 a[4:7], v5, s[20:23], s56 offen offset:128 nt
    s_waitcnt vmcnt(5)
    buffer_load_dwordx4 a[8:11], v5, s[20:23], s56 offen offset:256 nt
    v_mfma_f32_16x16x32_bf16 v[60:63], a[24:27], a[48:51], 0
    v_mfma_f32_16x16x32_bf16 v[60:63], a[28:31], a[52:55], v[60:63]
    v_mfma_f32_16x16x32_bf16 v[60:63], a[32:35], a[56:59], v[60:63]
    s_waitcnt vmcnt(5)
    buffer_load_dwordx4 a[12:15], v5, s[20:23], s57 offen offset:0 nt
    s_waitcnt vmcnt(5)
    buffer_load_dwordx4 a[16:19], v5, s[20:23], s57 offen offset:128 nt
    s_waitcnt vmcnt(5)
    buffer_load_dwordx4 a[20:23], v5, s[20:23], s57 offen offset:256 nt
    v_mfma_f32_16x16x32_bf16 v[68:71], a[36:39], a[48:51], 0
    v_mfma_f32_16x16x32_bf16 v[68:71], a[40:43], a[52:55], v[68:71]
    v_mfma_f32_16x16x32_bf16 v[68:71], a[44:47], a[56:59], v[68:71]
    s_waitcnt vmcnt(5)
    buffer_load_dwordx4 a[24:27], v5, s[20:23], s58 offen offset:0 nt
    s_nop 7
    v_add_f32_dpp v40, v57, v56 row_ror:8 row_mask:0xf bank_mask:0x3
    v_add_f32_dpp v40, v64, v65 row_ror:8 row_mask:0xf bank_mask:0xc
    v_add_f32_dpp v41, v59, v58 row_ror:8 row_mask:0xf bank_mask:0x3
    v_add_f32_dpp v41, v66, v67 row_ror:8 row_mask:0xf bank_mask:0xc
    v_add_f32_dpp v42, v61, v60 row_ror:8 row_mask:0xf bank_mask:0x3
    v_add_f32_dpp v42, v68, v69 row_ror:8 row_mask:0xf bank_mask:0xc
    v_add_f32_dpp v43, v63, v62 row_ror:8 row_mask:0xf bank_mask:0x3
    v_add_f32_dpp v43, v70, v71 row_ror:8 row_mask:0xf bank_mask:0xc
    v_mul_f32 v40, s46, v40
    v_mul_f32 v41, s46, v41
    v_mul_f32 v42, s46, v42
    s_waitcnt vmcnt(5)
    buffer_load_dwordx4 a[28:31], v5, s[20:23], s58 offen offset:128 nt
    v_mul_f32 v43, s46, v43
    v_cndmask_b32_e64 v40, v40, 0, s[60:61]
    v_cndmask_b32_e64 v41, v41, 0, s[60:61]
    v_cndmask_b32_e64 v42, v42, 0, s[60:61]
    v_cndmask_b32_e64 v43, v43, 0, s[60:61]
    v_cndmask_b32_e64 v40, v16, v40, s[80:81]
    v_cndmask_b32_e64 v41, v16, v41, s[80:81]
    v_cndmask_b32_e64 v42, v16, v42, s[84:85]
    v_cndmask_b32_e64 v43, v16, v43, s[84:85]
    ds_write_b128 v26, v[40:43] offset:20480
    v_max3_f32 v27, v40, v41, v27
    v_max3_f32 v27, v42, v43, v27
    v_add_u32 v26, 1024, v26
    s_waitcnt vmcnt(5)
    buffer_load_dwordx4 a[32:35], v5, s[20:23], s58 offen offset:256 nt
    v_mfma_f32_16x16x32_bf16 v[56:59], a[0:3], a[48:51], 0
    v_mfma_f32_16x16x32_bf16 v[56:59], a[4:7], a[52:55], v[56:59]
    v_mfma_f32_16x16x32_bf16 v[56:59], a[8:11], a[56:59], v[56:59]
    s_waitcnt vmcnt(5)
    buffer_load_dwordx4 a[36:39], v5, s[20:23], s59 offen offset:0 nt
    s_waitcnt vmcnt(5)
    buffer_load_dwordx4 a[40:43], v5, s[20:23], s59 offen offset:128 nt
    s_waitcnt vmcnt(5)
    buffer_load_dwordx4 a[44:47], v5, s[20:23], s59 offen offset:256 nt
    s_add_u32 s41, s41, 4
    s_cmp_lt_u32 s41, s40
    s_cbranch_scc1 L_kloop
L_kdone:
    s_mov_b32 s92, s42
    s_mov_b32 s41, 0
    v_readlane_b32 s42, v18, s41
    v_readlane_b32 s56, v17, s41
    s_add_u32 s49, s41, 1
    v_readlane_b32 s57, v17, s49
    s_add_u32 s49, s41, 2
    v_readlane_b32 s58, v17, s49
    s_add_u32 s49, s41, 3
    v_readlane_b32 s59, v17, s49
    s_nop 0
    s_mov_b32 s20, s8
    s_and_b32 s21, s9, 0xffff
    s_mov_b32 s22, s63
    s_waitcnt vmcnt(6)
    buffer_load_dwordx4 v[176:179], v6, s[24:27], s56 offen nt
    s_pack_ll_b32_b16 s80, s92, s92
    s_pack_hh_b32_b16 s84, s92, s92
    s_mov_b32 s81, s80
    s_mov_b32 s85, s84
    s_waitcnt vmcnt(7)
    buffer_load_dwordx2 v[180:181], v7, s[24:27], s56 offen nt
    v_mfma_f32_16x16x32_bf16 v[64:67], a[12:15], a[48:51], 0
    v_mfma_f32_16x16x32_bf16 v[64:67], a[16:19], a[52:55], v[64:67]
    v_mfma_f32_16x16x32_bf16 v[64:67], a[20:23], a[56:59], v[64:67]
    s_or_b32 s49, s36, s2
    s_cmp_lg_u32 s49, 0
    s_cbranch_scc1 L_nn2
    s_waitcnt lgkmcnt(0)
    s_add_u32 s90, s90, 0x01010101
    s_max_u32 s90, s90, 1
    v_mov_b32 v2, 0
    v_mov_b32 v3, s90
    s_mov_b64 exec, 1
    global_store_dword v2, v3, s[16:17] sc1
    s_mov_b64 exec, -1
L_nn2:
    s_waitcnt vmcnt(6)
    buffer_load_dwordx4 v[182:185], v8, s[24:27], s56 offen nt
    v_mov_b32 v30, v28
    s_nop 1
    v_permlane16_swap_b32 v28, v30
    s_nop 1
    v_max_f32 v28, v28, v30
    v_mov_b32 v30, v28
    s_nop 1
    v_permlane32_swap_b32 v28, v30
    s_nop 1
    v_max_f32 v28, v28, v30
    s_waitcnt vmcnt(7)
    buffer_load_dwordx2 v[186:187], v9, s[24:27], s56 offen nt
    v_sub_f32 v120, v120, v28
    v_sub_f32 v121, v121, v28
    v_sub_f32 v122, v122, v28
    v_sub_f32 v123, v123, v28
    v_sub_f32 v124, v124, v28
    v_sub_f32 v125, v125, v28
    v_sub_f32 v126, v126, v28
    v_sub_f32 v127, v127, v28
    v_exp_f32 v120, v120
    v_exp_f32 v121, v121
    v_exp_f32 v122, v122
    v_exp_f32 v123, v123
    v_exp_f32 v124, v124
    v_exp_f32 v125, v125
    v_exp_f32 v126, v126
    v_exp_f32 v127, v127
    s_waitcnt vmcnt(6)
    buffer_load_dwordx4 v[188:191], v6, s[24:27], s57 offen nt
    v_mfma_f32_16x16x32_bf16 v[60:63], a[24:27], a[48:51], 0
    v_mfma_f32_16x16x32_bf16 v[60:63], a[28:31], a[52:55], v[60:63]
    v_mfma_f32_16x16x32_bf16 v[60:63], a[32:35], a[56:59], v[60:63]
    s_nop 0
    v_add_f32 v2, v120, v121
    v_add_f32 v3, v122, v123
    v_add_f32 v4, v124, v125
    v_add_f32 v30, v126, v127
    v_cvt_pk_bf16_f32 v120, v120, v121
    v_cvt_pk_bf16_f32 v121, v122, v123
    v_cvt_pk_bf16_f32 v124, v124, v125
    v_cvt_pk_bf16_f32 v125, v126, v127
    v_add_f32 v2, v2, v3
    v_add_f32 v4, v4, v30
    v_add_f32 v37, v2, v4
    v_mov_b32 v2, v37
    s_mul_i32 s49, s36, 1600
    v_and_b32 v5, 800, v15
    v_permlane16_swap_b32 v37, v2
    v_lshrrev_b32 v4, 4, v1
    v_lshl_add_u32 v5, v4, 4, v5
    v_add_f32 v37, v37, v2
    v_mov_b32 v2, v37
    v_add_u32 v5, s49, v5
    s_lshl_b32 s48, 1, s53
    v_permlane32_swap_b32 v37, v2
    v_cmp_eq_u32 s[88:89], s48, v13
    v_mov_b32 v36, v28
    v_add_f32 v37, v37, v2
    s_and_b64 exec, s[88:89], 0xffff
    ds_write_b64 v5, v[36:37] offset:2048
    s_mov_b64 exec, -1
    s_mul_i32 s49, s36, 13312
    s_add_u32 s49, s49, 19200
    v_lshl_add_u32 v2, v1, 4, s49
    v_cndmask_b32_e64 v5, v2, v5, s[88:89]
    s_waitcnt vmcnt(7)
    buffer_load_dwordx2 v[192:193], v7, s[24:27], s57 offen nt
    s_waitcnt vmcnt(6)
    buffer_load_dwordx4 v[194:197], v8, s[24:27], s57 offen nt
    s_waitcnt vmcnt(7)
    buffer_load_dwordx2 v[198:199], v9, s[24:27], s57 offen nt
    v_mfma_f32_16x16x32_bf16 v[68:71], a[36:39], a[48:51], 0
    v_mfma_f32_16x16x32_bf16 v[68:71], a[40:43], a[52:55], v[68:71]
    v_mfma_f32_16x16x32_bf16 v[68:71], a[44:47], a[56:59], v[68:71]
    s_waitcnt vmcnt(6)
    buffer_load_dwordx4 v[200:203], v6, s[24:27], s58 offen nt
    s_nop 7
    v_add_f32_dpp v40, v57, v56 row_ror:8 row_mask:0xf bank_mask:0x3
    v_add_f32_dpp v40, v64, v65 row_ror:8 row_mask:0xf bank_mask:0xc
    v_add_f32_dpp v41, v59, v58 row_ror:8 row_mask:0xf bank_mask:0x3
    v_add_f32_dpp v41, v66, v67 row_ror:8 row_mask:0xf bank_mask:0xc
    v_add_f32_dpp v42, v61, v60 row_ror:8 row_mask:0xf bank_mask:0x3
    v_add_f32_dpp v42, v68, v69 row_ror:8 row_mask:0xf bank_mask:0xc
    v_add_f32_dpp v43, v63, v62 row_ror:8 row_mask:0xf bank_mask:0x3
    v_add_f32_dpp v43, v70, v71 row_ror:8 row_mask:0xf bank_mask:0xc
    v_mul_f32 v40, s46, v40
    v_mul_f32 v41, s46, v41
    v_mul_f32 v42, s46, v42
    s_waitcnt vmcnt(7)
    buffer_load_dwordx2 v[204:205], v7, s[24:27], s58 offen nt
    v_mul_f32 v43, s46, v43
    v_cndmask_b32_e64 v40, v40, 0, s[60:61]
    v_cndmask_b32_e64 v41, v41, 0, s[60:61]
    v_cndmask_b32_e64 v42, v42, 0, s[60:61]
    v_cndmask_b32_e64 v43, v43, 0, s[60:61]
    v_cndmask_b32_e64 v40, v16, v40, s[80:81]
    v_cndmask_b32_e64 v41, v16, v41, s[80:81]
    v_cndmask_b32_e64 v42, v16, v42, s[84:85]
    v_cndmask_b32_e64 v43, v16, v43, s[84:85]
    ds_write_b128 v26, v[40:43] offset:20480
    v_max3_f32 v27, v40, v41, v27
    v_max3_f32 v27, v42, v43, v27
    v_add_u32 v26, 1024, v26
    s_waitcnt vmcnt(6)
    buffer_load_dwordx4 v[206:209], v8, s[24:27], s58 offen nt
    v_mov_b32 v30, v27
    s_nop 1
    v_permlane16_swap_b32 v27, v30
    s_nop 1
    v_max_f32 v27, v27, v30
    v_mov_b32 v30, v27
    s_nop 1
    v_permlane32_swap_b32 v27, v30
    s_nop 1
    v_max_f32 v27, v27, v30
    v_sub_f32 v23, v19, v27
    v_mov_b32 v19, v27
    v_exp_f32 v23, v23
    s_nop 0
    v_mul_f32 v20, v20, v23
    v_mul_f32 v128, v128, v23
    v_mul_f32 v129, v129, v23
    v_mul_f32 v130, v130, v23
    v_mul_f32 v131, v131, v23
    v_mul_f32 v132, v132, v23
    v_mul_f32 v133, v133, v23
    v_mul_f32 v134, v134, v23
    v_mul_f32 v135, v135, v23
    v_mul_f32 v136, v136, v23
    v_mul_f32 v137, v137, v23
    v_mul_f32 v138, v138, v23
    v_mul_f32 v139, v139, v23
    v_mul_f32 v140, v140, v23
    v_mul_f32 v141, v141, v23
    v_mul_f32 v142, v142, v23
    v_mul_f32 v143, v143, v23
    v_mul_f32 v144, v144, v23
    s_waitcnt vmcnt(7)
    buffer_load_dwordx2 v[210:211], v9, s[24:27], s58 offen nt
    v_mul_f32 v145, v145, v23
    v_mul_f32 v146, v146, v23
    v_mul_f32 v147, v147, v23
    v_mul_f32 v148, v148, v23
    v_mul_f32 v149, v149, v23
    v_mul_f32 v150, v150, v23
    v_mul_f32 v151, v151, v23
    v_mul_f32 v152, v152, v23
    v_mul_f32 v153, v153, v23
    v_mul_f32 v154, v154, v23
    v_mul_f32 v155, v155, v23
    v_mul_f32 v156, v156, v23
    v_mul_f32 v157, v157, v23
    v_mul_f32 v158, v158, v23
    v_mul_f32 v159, v159, v23
    v_mul_f32 v160, v160, v23
    v_mul_f32 v161, v161, v23
    v_mul_f32 v162, v162, v23
    v_mul_f32 v163, v163, v23
    v_mul_f32 v164, v164, v23
    v_mul_f32 v165, v165, v23
    v_mul_f32 v166, v166, v23
    v_mul_f32 v167, v167, v23
    v_mul_f32 v168, v168, v23
    v_mul_f32 v169, v169, v23
    v_mul_f32 v170, v170, v23
    v_mul_f32 v171, v171, v23
    v_mul_f32 v172, v172, v23
    v_mul_f32 v173, v173, v23
    v_mul_f32 v174, v174, v23
    v_mul_f32 v175, v175, v23
    s_mul_i32 s49, s36, 13312
    v_lshl_add_u32 v26, v1, 4, s49
    v_perm_b32 v72, v182, v176, s44
    v_perm_b32 v76, v182, v176, s45
    v_perm_b32 v80, v183, v177, s44
    v_perm_b32 v84, v183, v177, s45
    v_perm_b32 v88, v184, v178, s44
    v_perm_b32 v92, v184, v178, s45
    v_perm_b32 v96, v185, v179, s44
    v_perm_b32 v100, v185, v179, s45
    v_perm_b32 v104, v186, v180, s44
    v_perm_b32 v108, v186, v180, s45
    v_perm_b32 v112, v187, v181, s44
    v_perm_b32 v116, v187, v181, s45
    s_waitcnt vmcnt(6)
    buffer_load_dwordx4 v[212:215], v6, s[24:27], s59 offen nt
    s_waitcnt vmcnt(7)
    buffer_load_dwordx2 v[216:217], v7, s[24:27], s59 offen nt
    s_waitcnt vmcnt(6)
    buffer_load_dwordx4 v[218:221], v8, s[24:27], s59 offen nt
    s_waitcnt vmcnt(7)
    buffer_load_dwordx2 v[222:223], v9, s[24:27], s59 offen nt
    s_mov_b32 s41, 4
    s_sub_i32 s50, s40, 0
    s_cmp_ge_i32 s41, s50
    s_cbranch_scc1 L_vl2c
L_vloop:
    v_readlane_b32 s42, v18, s41
    v_readlane_b32 s56, v17, s41
    s_add_u32 s49, s41, 1
    v_readlane_b32 s57, v17, s49
    s_add_u32 s49, s41, 2
    v_readlane_b32 s58, v17, s49
    s_add_u32 s49, s41, 3
    v_readlane_b32 s59, v17, s49
    s_nop 0
    s_waitcnt vmcnt(6)
    buffer_load_dwordx4 v[176:179], v6, s[24:27], s56 offen nt
    ds_read_b128 v[56:59], v26 offset:20480
    v_add_u32 v26, 1024, v26
    v_perm_b32 v74, v194, v188, s44
    v_perm_b32 v78, v194, v188, s45
    v_perm_b32 v82, v195, v189, s44
    v_perm_b32 v86, v195, v189, s45
    v_perm_b32 v90, v196, v190, s44
    v_perm_b32 v94, v196, v190, s45
    v_perm_b32 v98, v197, v191, s44
    v_perm_b32 v102, v197, v191, s45
    v_perm_b32 v106, v198, v192, s44
    v_perm_b32 v110, v198, v192, s45
    v_perm_b32 v114, v199, v193, s44
    v_perm_b32 v118, v199, v193, s45
    s_waitcnt vmcnt(7)
    buffer_load_dwordx2 v[180:181], v7, s[24:27], s56 offen nt
    s_waitcnt lgkmcnt(0)
    v_sub_f32 v40, v56, v19
    v_sub_f32 v41, v57, v19
    v_sub_f32 v42, v58, v19
    v_sub_f32 v43, v59, v19
    v_exp_f32 v40, v40
    v_exp_f32 v41, v41
    v_exp_f32 v42, v42
    v_exp_f32 v43, v43
    s_nop 0
    v_cvt_pk_bf16_f32 v36, v40, v41
    v_cvt_pk_bf16_f32 v37, v42, v43
    v_add_f32 v2, v40, v41
    v_add_f32 v3, v42, v43
    v_and_b32 v44, v36, v14
    v_and_b32 v45, v37, v14
    v_and_b32 v46, v36, v15
    v_and_b32 v47, v37, v15
    v_add_f32 v2, v2, v3
    v_add_f32 v20, v20, v2
    s_waitcnt vmcnt(6)
    buffer_load_dwordx4 v[182:185], v8, s[24:27], s56 offen nt
    s_waitcnt vmcnt(7)
    buffer_load_dwordx2 v[186:187], v9, s[24:27], s56 offen nt
    v_perm_b32 v73, v206, v200, s44
    v_perm_b32 v77, v206, v200, s45
    v_perm_b32 v81, v207, v201, s44
    v_perm_b32 v85, v207, v201, s45
    v_perm_b32 v89, v208, v202, s44
    v_perm_b32 v93, v208, v202, s45
    v_perm_b32 v97, v209, v203, s44
    v_perm_b32 v101, v209, v203, s45
    v_perm_b32 v105, v210, v204, s44
    v_perm_b32 v109, v210, v204, s45
    v_perm_b32 v113, v211, v205, s44
    v_perm_b32 v117, v211, v205, s45
    s_waitcnt vmcnt(6)
    buffer_load_dwordx4 v[188:191], v6, s[24:27], s57 offen nt
    s_waitcnt vmcnt(7)
    buffer_load_dwordx2 v[192:193], v7, s[24:27], s57 offen nt
    s_waitcnt vmcnt(6)
    buffer_load_dwordx4 v[194:197], v8, s[24:27], s57 offen nt
    s_waitcnt vmcnt(7)
    buffer_load_dwordx2 v[198:199], v9, s[24:27], s57 offen nt
    v_perm_b32 v75, v218, v212, s44
    v_perm_b32 v79, v218, v212, s45
    v_perm_b32 v83, v219, v213, s44
    v_perm_b32 v87, v219, v213, s45
    v_perm_b32 v91, v220, v214, s44
    v_perm_b32 v95, v220, v214, s45
    v_perm_b32 v99, v221, v215, s44
    v_perm_b32 v103, v221, v215, s45
    v_perm_b32 v107, v222, v216, s44
    v_perm_b32 v111, v222, v216, s45
    v_perm_b32 v115, v223, v217, s44
    v_perm_b32 v119, v223, v217, s45
    s_nop 1
    v_mfma_f32_16x16x32_bf16 v[128:131], v[72:75], v[44:47], v[128:131]
    v_mfma_f32_16x16x32_bf16 v[132:135], v[76:79], v[44:47], v[132:135]
    v_mfma_f32_16x16x32_bf16 v[136:139], v[80:83], v[44:47], v[136:139]
    v_mfma_f32_16x16x32_bf16 v[140:143], v[84:87], v[44:47], v[140:143]
    v_mfma_f32_16x16x32_bf16 v[144:147], v[88:91], v[44:47], v[144:147]
    s_waitcnt vmcnt(6)
    buffer_load_dwordx4 v[200:203], v6, s[24:27], s58 offen nt
    v_mfma_f32_16x16x32_bf16 v[148:151], v[92:95], v[44:47], v[148:151]
    v_mfma_f32_16x16x32_bf16 v[152:155], v[96:99], v[44:47], v[152:155]
    v_mfma_f32_16x16x32_bf16 v[156:159], v[100:103], v[44:47], v[156:159]
    v_mfma_f32_16x16x32_bf16 v[160:163], v[104:107], v[44:47], v[160:163]
    v_mfma_f32_16x16x32_bf16 v[164:167], v[108:111], v[44:47], v[164:167]
    v_mfma_f32_16x16x32_bf16 v[168:171], v[112:115], v[44:47], v[168:171]
    v_mfma_f32_16x16x32_bf16 v[172:175], v[116:119], v[44:47], v[172:175]
    s_waitcnt vmcnt(7)
    buffer_load_dwordx2 v[204:205], v7, s[24:27], s58 offen nt
    s_waitcnt vmcnt(6)
    buffer_load_dwordx4 v[206:209], v8, s[24:27], s58 offen nt
    s_waitcnt vmcnt(7)
    buffer_load_dwordx2 v[210:211], v9, s[24:27], s58 offen nt
    v_perm_b32 v72, v182, v176, s44
    v_perm_b32 v76, v182, v176, s45
    v_perm_b32 v80, v183, v177, s44
    v_perm_b32 v84, v183, v177, s45
    v_perm_b32 v88, v184, v178, s44
    v_perm_b32 v92, v184, v178, s45
    v_perm_b32 v96, v185, v179, s44
    v_perm_b32 v100, v185, v179, s45
    v_perm_b32 v104, v186, v180, s44
    v_perm_b32 v108, v186, v180, s45
    v_perm_b32 v112, v187, v181, s44
    v_perm_b32 v116, v187, v181, s45
    s_waitcnt vmcnt(6)
    buffer_load_dwordx4 v[212:215], v6, s[24:27], s59 offen nt
    s_waitcnt vmcnt(7)
    buffer_load_dwordx2 v[216:217], v7, s[24:27], s59 offen nt
    s_waitcnt vmcnt(6)
    buffer_load_dwordx4 v[218:221], v8, s[24:27], s59 offen nt
    s_waitcnt vmcnt(7)
    buffer_load_dwordx2 v[222:223], v9, s[24:27], s59 offen nt
    s_add_u32 s41, s41, 4
    s_cmp_lt_i32 s41, s50
    s_cbranch_scc1 L_vloop
L_vl2c:
L_vdone:
    s_waitcnt vmcnt(8)
    buffer_load_dwordx4 v[176:179], v6, s[24:27], s94 offen nt
    ds_read_b128 v[56:59], v26 offset:20480
    v_add_u32 v26, 1024, v26
    v_perm_b32 v74, v194, v188, s44
    v_perm_b32 v78, v194, v188, s45
    v_perm_b32 v82, v195, v189, s44
    v_perm_b32 v86, v195, v189, s45
    v_perm_b32 v90, v196, v190, s44
    v_perm_b32 v94, v196, v190, s45
    v_perm_b32 v98, v197, v191, s44
    v_perm_b32 v102, v197, v191, s45
    v_perm_b32 v106, v198, v192, s44
    v_perm_b32 v110, v198, v192, s45
    v_perm_b32 v114, v199, v193, s44
    v_perm_b32 v118, v199, v193, s45
    v_mov_b32 v33, 0
    global_load_dword v32, v33, s[16:17] sc1
    s_waitcnt vmcnt(8)
    buffer_load_dwordx2 v[180:181], v7, s[24:27], s94 offen nt
    s_waitcnt lgkmcnt(0)
    v_sub_f32 v40, v56, v19
    v_sub_f32 v41, v57, v19
    v_sub_f32 v42, v58, v19
    v_sub_f32 v43, v59, v19
    v_exp_f32 v40, v40
    v_exp_f32 v41, v41
    v_exp_f32 v42, v42
    v_exp_f32 v43, v43
    s_nop 0
    v_cvt_pk_bf16_f32 v36, v40, v41
    v_cvt_pk_bf16_f32 v37, v42, v43
    v_add_f32 v2, v40, v41
    v_add_f32 v3, v42, v43
    v_and_b32 v44, v36, v14
    v_and_b32 v45, v37, v14
    v_and_b32 v46, v36, v15
    v_and_b32 v47, v37, v15
    v_add_f32 v2, v2, v3
    v_add_f32 v20, v20, v2
    s_waitcnt vmcnt(8)
    buffer_load_dwordx4 v[182:185], v8, s[24:27], s94 offen nt
    s_waitcnt vmcnt(8)
    buffer_load_dwordx2 v[186:187], v9, s[24:27], s94 offen nt
    s_waitcnt vmcnt(8)
    buffer_load_dwordx4 v[188:191], v6, s[24:27], s95 offen nt
    v_perm_b32 v73, v206, v200, s44
    v_perm_b32 v77, v206, v200, s45
    v_perm_b32 v81, v207, v201, s44
    v_perm_b32 v85, v207, v201, s45
    v_perm_b32 v89, v208, v202, s44
    v_perm_b32 v93, v208, v202, s45
    v_perm_b32 v97, v209, v203, s44
    v_perm_b32 v101, v209, v203, s45
    v_perm_b32 v105, v210, v204, s44
    v_perm_b32 v109, v210, v204, s45
    v_perm_b32 v113, v211, v205, s44
    v_perm_b32 v117, v211, v205, s45
    s_and_b32 s49, s36, 1
    s_lshr_b32 s48, s36, 1
    s_lshr_b32 s65, s43, s48
    s_lshl_b32 s64, s48, 5
    s_add_u32 s64, s64, s49
    s_lshl_b32 s71, s51, 1
    s_add_u32 s64, s64, s71
    s_lshl_b32 s64, s64, 4
    s_add_u32 s64, s64, s38
    s_lshl_b32 s64, s64, 10
    s_mul_i32 s49, s49, 13312
    s_mul_i32 s48, s48, 784
    s_add_u32 s49, s49, s48
    s_add_u32 s49, s49, 20480
    v_mov_b32 v21, s49
    v_min_u32 v17, 48, v1
    v_lshlrev_b32 v17, 4, v17
    v_add_u32 v22, s49, v17
    v_cmp_gt_u32 vcc, 49, v1
    v_mov_b32 v2, 0x80000000
    v_cmp_eq_u32 s[66:67], 48, v1
    v_cndmask_b32 v25, v2, v17, vcc
    s_mov_b32 s68, 0x07060500
    s_mov_b32 s69, 0x07060501
    s_mov_b32 s76, 0x07060502
    s_mov_b32 s77, 0x07060503
    s_lshl_b32 s49, s53, 5
    s_add_u32 s49, s49, s71
    s_and_b32 s48, s38, 1
    s_add_u32 s49, s49, s48
    s_mul_i32 s47, s49, 384
    s_lshl_b32 s71, s49, 14
    s_lshl_b32 s49, s36, 10
    s_add_u32 s71, s71, s49
    s_mov_b32 s70, s72
    s_bitset0_b32 s70, s38
    s_lshr_b32 s70, s70, s36
    s_and_b32 s70, s70, 0x1111
    s_mul_i32 s49, s36, 800
    v_add_u32 v31, s49, v17
    s_lshr_b32 s78, s38, 2
    s_and_b32 s49, s38, 3
    s_cmp_eq_u32 s49, s36
    s_cselect_b32 s78, s78, 9
    s_waitcnt vmcnt(8)
    buffer_load_dwordx2 v[192:193], v7, s[24:27], s95 offen nt
    v_lshrrev_b32 v2, 2, v1
    v_and_b32 v3, 3, v1
    v_lshl_add_u32 v4, v3, 5, v2
    v_lshl_add_u32 v3, v3, 4, v2
    v_add_u32 v3, 120, v3
    v_cmp_gt_u32 vcc, 8, v2
    v_mov_b32 v29, 16
    v_mov_b32 v30, 8
    v_cndmask_b32 v4, v3, v4, vcc
    v_cndmask_b32 v29, v30, v29, vcc
    v_lshlrev_b32 v52, 1, v4
    v_add_u32 v53, v52, v29
    v_add_u32 v54, v53, v29
    v_add_u32 v55, v54, v29
    v_min_u32 v34, 47, v1
    v_lshlrev_b32 v34, 4, v34
    v_mov_b32 v48, 0
    v_mov_b32 v49, 0
    v_mov_b32 v50, 0
    v_mov_b32 v51, 0
    v_min_u32 v10, 23, v1
    v_mul_u32_u24 v10, 800, v10
    v_mov_b32 v11, 0xf149f2ca
    s_waitcnt vmcnt(8)
    buffer_load_dwordx4 v[194:197], v8, s[24:27], s95 offen nt
    s_waitcnt vmcnt(8)
    buffer_load_dwordx2 v[198:199], v9, s[24:27], s95 offen nt
    s_waitcnt vmcnt(8)
    buffer_load_dwordx4 v[200:203], v6, s[24:27], s96 offen nt
    v_perm_b32 v75, v218, v212, s44
    v_perm_b32 v79, v218, v212, s45
    v_perm_b32 v83, v219, v213, s44
    v_perm_b32 v87, v219, v213, s45
    v_perm_b32 v91, v220, v214, s44
    v_perm_b32 v95, v220, v214, s45
    v_perm_b32 v99, v221, v215, s44
    v_perm_b32 v103, v221, v215, s45
    v_perm_b32 v107, v222, v216, s44
    v_perm_b32 v111, v222, v216, s45
    v_perm_b32 v115, v223, v217, s44
    v_perm_b32 v119, v223, v217, s45
    s_nop 1
    v_mfma_f32_16x16x32_bf16 v[128:131], v[72:75], v[44:47], v[128:131]
    v_mfma_f32_16x16x32_bf16 v[132:135], v[76:79], v[44:47], v[132:135]
    v_mfma_f32_16x16x32_bf16 v[136:139], v[80:83], v[44:47], v[136:139]
    v_mfma_f32_16x16x32_bf16 v[140:143], v[84:87], v[44:47], v[140:143]
    v_mfma_f32_16x16x32_bf16 v[144:147], v[88:91], v[44:47], v[144:147]
    s_waitcnt vmcnt(8)
    buffer_load_dwordx2 v[204:205], v7, s[24:27], s96 offen nt
    v_mfma_f32_16x16x32_bf16 v[148:151], v[92:95], v[44:47], v[148:151]
    v_mfma_f32_16x16x32_bf16 v[152:155], v[96:99], v[44:47], v[152:155]
    v_mfma_f32_16x16x32_bf16 v[156:159], v[100:103], v[44:47], v[156:159]
    v_mfma_f32_16x16x32_bf16 v[160:163], v[104:107], v[44:47], v[160:163]
    v_mfma_f32_16x16x32_bf16 v[164:167], v[108:111], v[44:47], v[164:167]
    v_mfma_f32_16x16x32_bf16 v[168:171], v[112:115], v[44:47], v[168:171]
    v_mfma_f32_16x16x32_bf16 v[172:175], v[116:119], v[44:47], v[172:175]
    s_nop 7
    v_mov_b32 v37, v20
    v_mov_b32 v3, v20
    v_and_b32 v2, 15, v1
    s_mul_i32 s49, s36, 13312
    v_permlane16_swap_b32 v37, v3
    v_mul_u32_u24 v2, 784, v2
    v_add_u32 v2, s49, v2
    v_add_f32 v37, v37, v3
    v_mov_b32 v3, v37
    v_lshrrev_b32 v4, 4, v1
    v_lshl_add_u32 v2, v4, 4, v2
    v_permlane32_swap_b32 v37, v3
    v_and_b32 v4, s43, v13
    v_cmp_ne_u32 vcc, 0, v4
    v_add_f32 v37, v37, v3
    v_mov_b32 v36, v19
    s_mov_b64 exec, vcc
    ds_write_b128 v2, v[128:131] offset:20480
    ds_write_b128 v2, v[132:135] offset:20544
    ds_write_b128 v2, v[136:139] offset:20608
    ds_write_b128 v2, v[140:143] offset:20672
    ds_write_b128 v2, v[144:147] offset:20736
    ds_write_b128 v2, v[148:151] offset:20800
    ds_write_b128 v2, v[152:155] offset:20864
    ds_write_b128 v2, v[156:159] offset:20928
    ds_write_b128 v2, v[160:163] offset:20992
    ds_write_b128 v2, v[164:167] offset:21056
    ds_write_b128 v2, v[168:171] offset:21120
    ds_write_b128 v2, v[172:175] offset:21184
    s_and_b64 exec, vcc, 0xffff
    ds_write_b64 v2, v[36:37] offset:21248
    s_mov_b64 exec, -1
    v_readfirstlane_b32 s55, v32
    s_mov_b32 s91, 0
L_tag:
    s_cmp_lg_u32 s55, 0
    s_cbranch_scc1 L_tagd
    global_load_dword v32, v33, s[16:17] sc1
    s_add_u32 s91, s91, 1
    s_waitcnt vmcnt(0)
    v_readfirstlane_b32 s55, v32
    s_cmp_lt_u32 s91, 20000
    s_cbranch_scc1 L_tag
L_tagd:
    s_mov_b32 s91, 0
    v_mov_b32 v27, s55
    s_waitcnt lgkmcnt(0)
    s_barrier
    s_bitcmp0_b32 s65, 0
    s_cbranch_scc1 L_pk0
    ds_read_b32 v40, v21 offset:768
    ds_read_b32 v41, v21 offset:7040
    ds_read_b32 v42, v21 offset:27392
    ds_read_b32 v43, v21 offset:33664
    ds_read_b128 v[56:59], v22 offset:0
    ds_read_b128 v[60:63], v22 offset:6272
    ds_read_b128 v[64:67], v22 offset:26624
    ds_read_b128 v[68:71], v22 offset:32896
    s_waitcnt lgkmcnt(4)
    v_max3_f32 v29, v40, v41, v42
    v_max_f32 v29, v29, v43
    v_sub_f32 v40, v40, v29
    v_sub_f32 v41, v41, v29
    v_sub_f32 v42, v42, v29
    v_sub_f32 v43, v43, v29
    v_exp_f32 v40, v40
    v_exp_f32 v41, v41
    v_exp_f32 v42, v42
    v_exp_f32 v43, v43
    s_waitcnt lgkmcnt(3)
    v_mul_f32 v56, v40, v56
    v_mul_f32 v57, v40, v57
    v_mul_f32 v58, v40, v58
    v_mul_f32 v59, v40, v59
    s_waitcnt lgkmcnt(2)
    v_fmac_f32 v56, v41, v60
    v_fmac_f32 v57, v41, v61
    v_fmac_f32 v58, v41, v62
    v_fmac_f32 v59, v41, v63
    s_waitcnt lgkmcnt(1)
    v_fmac_f32 v56, v42, v64
    v_fmac_f32 v57, v42, v65
    v_fmac_f32 v58, v42, v66
    v_fmac_f32 v59, v42, v67
    s_waitcnt lgkmcnt(0)
    v_fmac_f32 v56, v43, v68
    v_fmac_f32 v57, v43, v69
    v_fmac_f32 v58, v43, v70
    v_fmac_f32 v59, v43, v71
    v_perm_b32 v60, v56, v27, s68
    v_perm_b32 v61, v57, v27, s69
    v_perm_b32 v62, v58, v27, s76
    v_perm_b32 v63, v59, v27, s77
    v_cndmask_b32_e64 v60, v60, v29, s[66:67]
    v_cndmask_b32_e64 v61, v61, v57, s[66:67]
    v_cndmask_b32_e64 v62, v62, v27, s[66:67]
    v_cndmask_b32_e64 v63, v63, v27, s[66:67]
    s_cmp_eq_u32 s78, 0
    s_cbranch_scc1 L_po0
    buffer_store_dwordx4 v[60:63], v25, s[32:35], s64 offen sc1
    s_branch L_pk0
L_po0:
    s_mov_b32 exec_hi, 0x1ffff
    ds_write_b128 v31, v[60:63] offset:7680
    s_mov_b32 exec_hi, -1
L_pk0:
    s_add_u32 s64, s64, 1048576
    s_bitcmp0_b32 s65, 2
    s_cbranch_scc1 L_pk1
    ds_read_b32 v40, v21 offset:2336
    ds_read_b32 v41, v21 offset:8608
    ds_read_b32 v42, v21 offset:28960
    ds_read_b32 v43, v21 offset:35232
    ds_read_b128 v[224:227], v22 offset:1568
    ds_read_b128 v[228:231], v22 offset:7840
    ds_read_b128 v[232:235], v22 offset:28192
    ds_read_b128 v[236:239], v22 offset:34464
    s_waitcnt lgkmcnt(4)
    v_max3_f32 v29, v40, v41, v42
    v_max_f32 v29, v29, v43
    v_sub_f32 v40, v40, v29
    v_sub_f32 v41, v41, v29
    v_sub_f32 v42, v42, v29
    v_sub_f32 v43, v43, v29
    v_exp_f32 v40, v40
    v_exp_f32 v41, v41
    v_exp_f32 v42, v42
    v_exp_f32 v43, v43
    s_waitcnt lgkmcnt(3)
    v_mul_f32 v224, v40, v224
    v_mul_f32 v225, v40, v225
    v_mul_f32 v226, v40, v226
    v_mul_f32 v227, v40, v227
    s_waitcnt lgkmcnt(2)
    v_fmac_f32 v224, v41, v228
    v_fmac_f32 v225, v41, v229
    v_fmac_f32 v226, v41, v230
    v_fmac_f32 v227, v41, v231
    s_waitcnt lgkmcnt(1)
    v_fmac_f32 v224, v42, v232
    v_fmac_f32 v225, v42, v233
    v_fmac_f32 v226, v42, v234
    v_fmac_f32 v227, v42, v235
    s_waitcnt lgkmcnt(0)
    v_fmac_f32 v224, v43, v236
    v_fmac_f32 v225, v43, v237
    v_fmac_f32 v226, v43, v238
    v_fmac_f32 v227, v43, v239
    v_perm_b32 v228, v224, v27, s68
    v_perm_b32 v229, v225, v27, s69
    v_perm_b32 v230, v226, v27, s76
    v_perm_b32 v231, v227, v27, s77
    v_cndmask_b32_e64 v228, v228, v29, s[66:67]
    v_cndmask_b32_e64 v229, v229, v225, s[66:67]
    v_cndmask_b32_e64 v230, v230, v27, s[66:67]
    v_cndmask_b32_e64 v231, v231, v27, s[66:67]
    s_cmp_eq_u32 s78, 1
    s_cbranch_scc1 L_po1
    buffer_store_dwordx4 v[228:231], v25, s[32:35], s64 offen sc1
    s_branch L_pk1
L_po1:
    s_mov_b32 exec_hi, 0x1ffff
    ds_write_b128 v31, v[228:231] offset:10880
    s_mov_b32 exec_hi, -1
L_pk1:
    s_add_u32 s64, s64, 1048576
    s_bitcmp0_b32 s65, 4
    s_cbranch_scc1 L_pk2
    ds_read_b32 v40, v21 offset:3904
    ds_read_b32 v41, v21 offset:10176
    ds_read_b32 v42, v21 offset:30528
    ds_read_b32 v43, v21 offset:36800
    ds_read_b128 v[56:59], v22 offset:3136
    ds_read_b128 v[60:63], v22 offset:9408
    ds_read_b128 v[64:67], v22 offset:29760
    ds_read_b128 v[68:71], v22 offset:36032
    s_waitcnt lgkmcnt(4)
    v_max3_f32 v29, v40, v41, v42
    v_max_f32 v29, v29, v43
    v_sub_f32 v40, v40, v29
    v_sub_f32 v41, v41, v29
    v_sub_f32 v42, v42, v29
    v_sub_f32 v43, v43, v29
    v_exp_f32 v40, v40
    v_exp_f32 v41, v41
    v_exp_f32 v42, v42
    v_exp_f32 v43, v43
    s_waitcnt lgkmcnt(3)
    v_mul_f32 v56, v40, v56
    v_mul_f32 v57, v40, v57
    v_mul_f32 v58, v40, v58
    v_mul_f32 v59, v40, v59
    s_waitcnt lgkmcnt(2)
    v_fmac_f32 v56, v41, v60
    v_fmac_f32 v57, v41, v61
    v_fmac_f32 v58, v41, v62
    v_fmac_f32 v59, v41, v63
    s_waitcnt lgkmcnt(1)
    v_fmac_f32 v56, v42, v64
    v_fmac_f32 v57, v42, v65
    v_fmac_f32 v58, v42, v66
    v_fmac_f32 v59, v42, v67
    s_waitcnt lgkmcnt(0)
    v_fmac_f32 v56, v43, v68
    v_fmac_f32 v57, v43, v69
    v_fmac_f32 v58, v43, v70
    v_fmac_f32 v59, v43, v71
    v_perm_b32 v60, v56, v27, s68
    v_perm_b32 v61, v57, v27, s69
    v_perm_b32 v62, v58, v27, s76
    v_perm_b32 v63, v59, v27, s77
    v_cndmask_b32_e64 v60, v60, v29, s[66:67]
    v_cndmask_b32_e64 v61, v61, v57, s[66:67]
    v_cndmask_b32_e64 v62, v62, v27, s[66:67]
    v_cndmask_b32_e64 v63, v63, v27, s[66:67]
    s_cmp_eq_u32 s78, 2
    s_cbranch_scc1 L_po2
    buffer_store_dwordx4 v[60:63], v25, s[32:35], s64 offen sc1
    s_branch L_pk2
L_po2:
    s_mov_b32 exec_hi, 0x1ffff
    ds_write_b128 v31, v[60:63] offset:14080
    s_mov_b32 exec_hi, -1
L_pk2:
    s_add_u32 s64, s64, 1048576
    s_bitcmp0_b32 s65, 6
    s_cbranch_scc1 L_pk3
    ds_read_b32 v40, v21 offset:5472
    ds_read_b32 v41, v21 offset:11744
    ds_read_b32 v42, v21 offset:32096
    ds_read_b32 v43, v21 offset:38368
    ds_read_b128 v[224:227], v22 offset:4704
    ds_read_b128 v[228:231], v22 offset:10976
    ds_read_b128 v[232:235], v22 offset:31328
    ds_read_b128 v[236:239], v22 offset:37600
    s_waitcnt lgkmcnt(4)
    v_max3_f32 v29, v40, v41, v42
    v_max_f32 v29, v29, v43
    v_sub_f32 v40, v40, v29
    v_sub_f32 v41, v41, v29
    v_sub_f32 v42, v42, v29
    v_sub_f32 v43, v43, v29
    v_exp_f32 v40, v40
    v_exp_f32 v41, v41
    v_exp_f32 v42, v42
    v_exp_f32 v43, v43
    s_waitcnt lgkmcnt(3)
    v_mul_f32 v224, v40, v224
    v_mul_f32 v225, v40, v225
    v_mul_f32 v226, v40, v226
    v_mul_f32 v227, v40, v227
    s_waitcnt lgkmcnt(2)
    v_fmac_f32 v224, v41, v228
    v_fmac_f32 v225, v41, v229
    v_fmac_f32 v226, v41, v230
    v_fmac_f32 v227, v41, v231
    s_waitcnt lgkmcnt(1)
    v_fmac_f32 v224, v42, v232
    v_fmac_f32 v225, v42, v233
    v_fmac_f32 v226, v42, v234
    v_fmac_f32 v227, v42, v235
    s_waitcnt lgkmcnt(0)
    v_fmac_f32 v224, v43, v236
    v_fmac_f32 v225, v43, v237
    v_fmac_f32 v226, v43, v238
    v_fmac_f32 v227, v43, v239
    v_perm_b32 v228, v224, v27, s68
    v_perm_b32 v229, v225, v27, s69
    v_perm_b32 v230, v226, v27, s76
    v_perm_b32 v231, v227, v27, s77
    v_cndmask_b32_e64 v228, v228, v29, s[66:67]
    v_cndmask_b32_e64 v229, v229, v225, s[66:67]
    v_cndmask_b32_e64 v230, v230, v27, s[66:67]
    v_cndmask_b32_e64 v231, v231, v27, s[66:67]
    s_cmp_eq_u32 s78, 3
    s_cbranch_scc1 L_po3
    buffer_store_dwordx4 v[228:231], v25, s[32:35], s64 offen sc1
    s_branch L_pk3
L_po3:
    s_mov_b32 exec_hi, 0x1ffff
    ds_write_b128 v31, v[228:231] offset:17280
    s_mov_b32 exec_hi, -1
L_pk3:
    s_waitcnt vmcnt(8)
    buffer_load_dwordx4 v[206:209], v8, s[24:27], s96 offen nt
    v_mov_b32 v128, 0
    v_mov_b32 v129, 0
    v_mov_b32 v130, 0
    v_mov_b32 v131, 0
    v_mov_b32 v132, 0
    v_mov_b32 v133, 0
    v_mov_b32 v134, 0
    v_mov_b32 v135, 0
    v_mov_b32 v136, 0
    v_mov_b32 v137, 0
    v_mov_b32 v138, 0
    v_mov_b32 v139, 0
    v_mov_b32 v140, 0
    v_mov_b32 v141, 0
    v_mov_b32 v142, 0
    v_mov_b32 v143, 0
    v_mov_b32 v144, 0
    v_mov_b32 v145, 0
    v_mov_b32 v146, 0
    v_mov_b32 v147, 0
    v_mov_b32 v148, 0
    v_mov_b32 v149, 0
    v_mov_b32 v150, 0
    v_mov_b32 v151, 0
    s_waitcnt vmcnt(8)
    buffer_load_dwordx2 v[210:211], v9, s[24:27], s96 offen nt
    v_mov_b32 v152, 0
    v_mov_b32 v153, 0
    v_mov_b32 v154, 0
    v_mov_b32 v155, 0
    v_mov_b32 v156, 0
    v_mov_b32 v157, 0
    v_mov_b32 v158, 0
    v_mov_b32 v159, 0
    v_mov_b32 v160, 0
    v_mov_b32 v161, 0
    v_mov_b32 v162, 0
    v_mov_b32 v163, 0
    v_mov_b32 v164, 0
    v_mov_b32 v165, 0
    v_mov_b32 v166, 0
    v_mov_b32 v167, 0
    v_mov_b32 v168, 0
    v_mov_b32 v169, 0
    v_mov_b32 v170, 0
    v_mov_b32 v171, 0
    v_mov_b32 v172, 0
    v_mov_b32 v173, 0
    v_mov_b32 v174, 0
    v_mov_b32 v175, 0
    s_waitcnt vmcnt(8)
    buffer_load_dwordx4 v[212:215], v6, s[24:27], s97 offen nt
    v_perm_b32 v72, v182, v176, s44
    v_perm_b32 v76, v182, v176, s45
    v_perm_b32 v80, v183, v177, s44
    v_perm_b32 v84, v183, v177, s45
    v_perm_b32 v88, v184, v178, s44
    v_perm_b32 v92, v184, v178, s45
    v_perm_b32 v96, v185, v179, s44
    v_perm_b32 v100, v185, v179, s45
    v_perm_b32 v104, v186, v180, s44
    v_perm_b32 v108, v186, v180, s45
    v_perm_b32 v112, v187, v181, s44
    v_perm_b32 v116, v187, v181, s45
    s_waitcnt vmcnt(8)
    buffer_load_dwordx2 v[216:217], v7, s[24:27], s97 offen nt
    s_waitcnt vmcnt(8)
    buffer_load_dwordx4 v[218:221], v8, s[24:27], s97 offen nt
    s_waitcnt vmcnt(8)
    buffer_load_dwordx2 v[222:223], v9, s[24:27], s97 offen nt
    s_waitcnt vmcnt(8)
    buffer_load_dwordx4 v[176:179], v6, s[24:27], s98 offen nt
    v_perm_b32 v74, v194, v188, s44
    v_perm_b32 v78, v194, v188, s45
    v_perm_b32 v82, v195, v189, s44
    v_perm_b32 v86, v195, v189, s45
    v_perm_b32 v90, v196, v190, s44
    v_perm_b32 v94, v196, v190, s45
    v_perm_b32 v98, v197, v191, s44
    v_perm_b32 v102, v197, v191, s45
    v_perm_b32 v106, v198, v192, s44
    v_perm_b32 v110, v198, v192, s45
    v_perm_b32 v114, v199, v193, s44
    v_perm_b32 v118, v199, v193, s45
    s_waitcnt vmcnt(8)
    buffer_load_dwordx2 v[180:181], v7, s[24:27], s98 offen nt
    v_and_b32 v44, v120, v14
    v_and_b32 v45, v121, v14
    v_and_b32 v46, v120, v15
    v_and_b32 v47, v121, v15
    s_waitcnt vmcnt(8)
    buffer_load_dwordx4 v[182:185], v8, s[24:27], s98 offen nt
    s_waitcnt vmcnt(8)
    buffer_load_dwordx2 v[186:187], v9, s[24:27], s98 offen nt
    s_waitcnt vmcnt(8)
    buffer_load_dwordx4 v[188:191], v6, s[24:27], s99 offen nt
    v_perm_b32 v73, v206, v200, s44
    v_perm_b32 v77, v206, v200, s45
    v_perm_b32 v81, v207, v201, s44
    v_perm_b32 v85, v207, v201, s45
    v_perm_b32 v89, v208, v202, s44
    v_perm_b32 v93, v208, v202, s45
    v_perm_b32 v97, v209, v203, s44
    v_perm_b32 v101, v209, v203, s45
    v_perm_b32 v105, v210, v204, s44
    v_perm_b32 v109, v210, v204, s45
    v_perm_b32 v113, v211, v205, s44
    v_perm_b32 v117, v211, v205, s45
    s_waitcnt vmcnt(8)
    buffer_load_dwordx2 v[192:193], v7, s[24:27], s99 offen nt
    s_waitcnt vmcnt(8)
    buffer_load_dwordx4 v[194:197], v8, s[24:27], s99 offen nt
    s_bitcmp0_b32 s70, 0
    s_cbranch_scc1 L_gi1_0
    s_add_u32 s49, s71, 0
    buffer_load_dwordx4 v[224:227], v25, s[32:35], s49 offen sc1
L_gi1_0:
    s_bitcmp0_b32 s70, 4
    s_cbranch_scc1 L_gi1_1
    s_add_u32 s49, s71, 4096
    buffer_load_dwordx4 v[228:231], v25, s[32:35], s49 offen sc1
L_gi1_1:
    s_bitcmp0_b32 s70, 8
    s_cbranch_scc1 L_gi1_2
    s_add_u32 s49, s71, 8192
    buffer_load_dwordx4 v[232:235], v25, s[32:35], s49 offen sc1
L_gi1_2:
    s_bitcmp0_b32 s70, 12
    s_cbranch_scc1 L_gi1_3
    s_add_u32 s49, s71, 12288
    buffer_load_dwordx4 v[236:239], v25, s[32:35], s49 offen sc1
L_gi1_3:
    s_waitcnt vmcnt(8)
    buffer_load_dwordx2 v[198:199], v9, s[24:27], s99 offen nt
    s_waitcnt vmcnt(8)
    buffer_load_dwordx4 v[200:203], v6, s[24:27], s100 offen nt
    v_perm_b32 v75, v218, v212, s44
    v_perm_b32 v79, v218, v212, s45
    v_perm_b32 v83, v219, v213, s44
    v_perm_b32 v87, v219, v213, s45
    v_perm_b32 v91, v220, v214, s44
    v_perm_b32 v95, v220, v214, s45
    v_perm_b32 v99, v221, v215, s44
    v_perm_b32 v103, v221, v215, s45
    v_perm_b32 v107, v222, v216, s44
    v_perm_b32 v111, v222, v216, s45
    v_perm_b32 v115, v223, v217, s44
    v_perm_b32 v119, v223, v217, s45
    s_nop 1
    v_mfma_f32_16x16x32_bf16 v[128:131], v[72:75], v[44:47], v[128:131]
    v_mfma_f32_16x16x32_bf16 v[132:135], v[76:79], v[44:47], v[132:135]
    v_mfma_f32_16x16x32_bf16 v[136:139], v[80:83], v[44:47], v[136:139]
    v_mfma_f32_16x16x32_bf16 v[140:143], v[84:87], v[44:47], v[140:143]
    v_mfma_f32_16x16x32_bf16 v[144:147], v[88:91], v[44:47], v[144:147]
    s_waitcnt vmcnt(8)
    buffer_load_dwordx2 v[204:205], v7, s[24:27], s100 offen nt
    v_mfma_f32_16x16x32_bf16 v[148:151], v[92:95], v[44:47], v[148:151]
    v_mfma_f32_16x16x32_bf16 v[152:155], v[96:99], v[44:47], v[152:155]
    v_mfma_f32_16x16x32_bf16 v[156:159], v[100:103], v[44:47], v[156:159]
    v_mfma_f32_16x16x32_bf16 v[160:163], v[104:107], v[44:47], v[160:163]
    v_mfma_f32_16x16x32_bf16 v[164:167], v[108:111], v[44:47], v[164:167]
    v_mfma_f32_16x16x32_bf16 v[168:171], v[112:115], v[44:47], v[168:171]
    v_mfma_f32_16x16x32_bf16 v[172:175], v[116:119], v[44:47], v[172:175]
    s_waitcnt vmcnt(8)
    buffer_load_dwordx4 v[206:209], v8, s[24:27], s100 offen nt
    s_waitcnt vmcnt(8)
    buffer_load_dwordx2 v[210:211], v9, s[24:27], s100 offen nt
    v_and_b32 v44, v124, v14
    v_and_b32 v45, v125, v14
    v_and_b32 v46, v124, v15
    v_and_b32 v47, v125, v15
    s_waitcnt vmcnt(8)
    buffer_load_dwordx4 v[212:215], v6, s[20:23], s101 offen nt
    v_perm_b32 v72, v182, v176, s44
    v_perm_b32 v76, v182, v176, s45
    v_perm_b32 v80, v183, v177, s44
    v_perm_b32 v84, v183, v177, s45
    v_perm_b32 v88, v184, v178, s44
    v_perm_b32 v92, v184, v178, s45
    v_perm_b32 v96, v185, v179, s44
    v_perm_b32 v100, v185, v179, s45
    v_perm_b32 v104, v186, v180, s44
    v_perm_b32 v108, v186, v180, s45
    v_perm_b32 v112, v187, v181, s44
    v_perm_b32 v116, v187, v181, s45
    s_waitcnt vmcnt(8)
    buffer_load_dwordx2 v[216:217], v7, s[20:23], s101 offen nt
    s_waitcnt vmcnt(8)
    buffer_load_dwordx4 v[218:221], v8, s[20:23], s101 offen nt
    s_waitcnt vmcnt(8)
    buffer_load_dwordx2 v[222:223], v9, s[20:23], s101 offen nt
    s_mov_b32 s64, 0x0c0c0400
    s_mov_b32 s65, 0x05040100
    s_waitcnt vmcnt(9)
    s_branch L_gchk
L_gissue:
    s_sleep 2
    s_bitcmp0_b32 s70, 0
    s_cbranch_scc1 L_gi2_0
    s_add_u32 s49, s71, 0
    buffer_load_dwordx4 v[224:227], v25, s[32:35], s49 offen sc1
L_gi2_0:
    s_bitcmp0_b32 s70, 4
    s_cbranch_scc1 L_gi2_1
    s_add_u32 s49, s71, 4096
    buffer_load_dwordx4 v[228:231], v25, s[32:35], s49 offen sc1
L_gi2_1:
    s_bitcmp0_b32 s70, 8
    s_cbranch_scc1 L_gi2_2
    s_add_u32 s49, s71, 8192
    buffer_load_dwordx4 v[232:235], v25, s[32:35], s49 offen sc1
L_gi2_2:
    s_bitcmp0_b32 s70, 12
    s_cbranch_scc1 L_gi2_3
    s_add_u32 s49, s71, 12288
    buffer_load_dwordx4 v[236:239], v25, s[32:35], s49 offen sc1
L_gi2_3:
    s_waitcnt vmcnt(0)
L_gchk:
    s_bitcmp0_b32 s70, 0
    s_cbranch_scc1 L_gc0
    v_perm_b32 v2, v225, v224, s64
    v_perm_b32 v3, v227, v226, s64
    v_and_b32 v4, v226, v227
    v_perm_b32 v2, v3, v2, s65
    v_cndmask_b32_e64 v2, v2, v4, s[66:67]
    v_cmp_ne_u32 vcc, s55, v2
    s_and_b32 vcc_hi, vcc_hi, 0x1ffff
    s_cmp_lg_u64 vcc, 0
    s_cbranch_scc1 L_gc0
    s_bitset0_b32 s70, 0
    s_mov_b32 exec_hi, 0x1ffff
    ds_write_b128 v31, v[224:227] offset:7680
    s_mov_b32 exec_hi, -1
L_gc0:
    s_bitcmp0_b32 s70, 4
    s_cbranch_scc1 L_gc1
    v_perm_b32 v2, v229, v228, s64
    v_perm_b32 v3, v231, v230, s64
    v_and_b32 v4, v230, v231
    v_perm_b32 v2, v3, v2, s65
    v_cndmask_b32_e64 v2, v2, v4, s[66:67]
    v_cmp_ne_u32 vcc, s55, v2
    s_and_b32 vcc_hi, vcc_hi, 0x1ffff
    s_cmp_lg_u64 vcc, 0
    s_cbranch_scc1 L_gc1
    s_bitset0_b32 s70, 4
    s_mov_b32 exec_hi, 0x1ffff
    ds_write_b128 v31, v[228:231] offset:10880
    s_mov_b32 exec_hi, -1
L_gc1:
    s_bitcmp0_b32 s70, 8
    s_cbranch_scc1 L_gc2
    v_perm_b32 v2, v233, v232, s64
    v_perm_b32 v3, v235, v234, s64
    v_and_b32 v4, v234, v235
    v_perm_b32 v2, v3, v2, s65
    v_cndmask_b32_e64 v2, v2, v4, s[66:67]
    v_cmp_ne_u32 vcc, s55, v2
    s_and_b32 vcc_hi, vcc_hi, 0x1ffff
    s_cmp_lg_u64 vcc, 0
    s_cbranch_scc1 L_gc2
    s_bitset0_b32 s70, 8
    s_mov_b32 exec_hi, 0x1ffff
    ds_write_b128 v31, v[232:235] offset:14080
    s_mov_b32 exec_hi, -1
L_gc2:
    s_bitcmp0_b32 s70, 12
    s_cbranch_scc1 L_gc3
    v_perm_b32 v2, v237, v236, s64
    v_perm_b32 v3, v239, v238, s64
    v_and_b32 v4, v238, v239
    v_perm_b32 v2, v3, v2, s65
    v_cndmask_b32_e64 v2, v2, v4, s[66:67]
    v_cmp_ne_u32 vcc, s55, v2
    s_and_b32 vcc_hi, vcc_hi, 0x1ffff
    s_cmp_lg_u64 vcc, 0
    s_cbranch_scc1 L_gc3
    s_bitset0_b32 s70, 12
    s_mov_b32 exec_hi, 0x1ffff
    ds_write_b128 v31, v[236:239] offset:17280
    s_mov_b32 exec_hi, -1
L_gc3:
    s_add_u32 s91, s91, 1
    s_cmp_ge_u32 s91, 20000
    s_cbranch_scc1 L_gdone
    s_cmp_lg_u32 s70, 0
    s_cbranch_scc1 L_gissue
L_gdone:
    s_waitcnt vmcnt(8)
    v_perm_b32 v74, v194, v188, s44
    v_perm_b32 v78, v194, v188, s45
    v_perm_b32 v82, v195, v189, s44
    v_perm_b32 v86, v195, v189, s45
    v_perm_b32 v90, v196, v190, s44
    v_perm_b32 v94, v196, v190, s45
    v_perm_b32 v98, v197, v191, s44
    v_perm_b32 v102, v197, v191, s45
    v_perm_b32 v106, v198, v192, s44
    v_perm_b32 v110, v198, v192, s45
    v_perm_b32 v114, v199, v193, s44
    v_perm_b32 v118, v199, v193, s45
    s_waitcnt lgkmcnt(0)
    s_barrier
    s_cmp_lg_u32 s36, 3
    s_cbranch_scc1 L_now
    ds_read_b64 v[36:37], v10 offset:2048
    s_lshl_b32 vcc_lo, s72, 8
    s_or_b32 vcc_lo, vcc_lo, 0xff
    s_mov_b32 vcc_hi, 0
    s_mov_b32 s65, s72
    s_ff1_i32_b32 s80, s65
    s_bitset0_b32 s65, s80
    s_max_i32 s49, s80, 0
    s_mul_i32 s48, s49, 800
    v_add_u32 v2, s48, v34
    ds_read_b128 v[56:59], v2 offset:7680
    s_ff1_i32_b32 s81, s65
    s_bitset0_b32 s65, s81
    s_max_i32 s49, s81, 0
    s_mul_i32 s48, s49, 800
    v_add_u32 v2, s48, v34
    ds_read_b128 v[60:63], v2 offset:7680
    s_ff1_i32_b32 s82, s65
    s_bitset0_b32 s65, s82
    s_max_i32 s49, s82, 0
    s_mul_i32 s48, s49, 800
    v_add_u32 v2, s48, v34
    ds_read_b128 v[64:67], v2 offset:7680
    s_ff1_i32_b32 s83, s65
    s_bitset0_b32 s65, s83
    s_max_i32 s49, s83, 0
    s_mul_i32 s48, s49, 800
    v_add_u32 v2, s48, v34
    ds_read_b128 v[68:71], v2 offset:7680
    s_ff1_i32_b32 s84, s65
    s_bitset0_b32 s65, s84
    s_max_i32 s49, s84, 0
    s_mul_i32 s48, s49, 800
    v_add_u32 v2, s48, v34
    ds_read_b128 v[224:227], v2 offset:7680
    s_ff1_i32_b32 s85, s65
    s_bitset0_b32 s65, s85
    s_max_i32 s49, s85, 0
    s_mul_i32 s48, s49, 800
    v_add_u32 v2, s48, v34
    ds_read_b128 v[228:231], v2 offset:7680
    s_ff1_i32_b32 s86, s65
    s_bitset0_b32 s65, s86
    s_max_i32 s49, s86, 0
    s_mul_i32 s48, s49, 800
    v_add_u32 v2, s48, v34
    ds_read_b128 v[232:235], v2 offset:7680
    s_ff1_i32_b32 s87, s65
    s_bitset0_b32 s65, s87
    s_max_i32 s49, s87, 0
    s_mul_i32 s48, s49, 800
    v_add_u32 v2, s48, v34
    ds_read_b128 v[236:239], v2 offset:7680
    s_ff1_i32_b32 s56, s65
    s_bitset0_b32 s65, s56
    s_max_i32 s49, s56, 0
    s_mul_i32 s48, s49, 800
    v_add_u32 v2, s48, v34
    ds_read_b128 v[240:243], v2 offset:7680
    s_ff1_i32_b32 s57, s65
    s_bitset0_b32 s65, s57
    s_max_i32 s49, s57, 0
    s_mul_i32 s48, s49, 800
    v_add_u32 v2, s48, v34
    ds_read_b128 v[244:247], v2 offset:7680
    s_ff1_i32_b32 s58, s65
    s_bitset0_b32 s65, s58
    s_max_i32 s49, s58, 0
    s_mul_i32 s48, s49, 800
    v_add_u32 v2, s48, v34
    ds_read_b128 v[248:251], v2 offset:7680
    s_ff1_i32_b32 s59, s65
    s_bitset0_b32 s65, s59
    s_max_i32 s49, s59, 0
    s_mul_i32 s48, s49, 800
    v_add_u32 v2, s48, v34
    ds_read_b128 v[252:255], v2 offset:7680
    s_waitcnt lgkmcnt(12)
    v_cndmask_b32 v36, v11, v36, vcc
    v_cndmask_b32_e64 v37, 0, v37, vcc
    v_mov_b32 v29, v36
    s_nop 1
    v_max_f32_dpp v29, v29, v29 row_ror:1 row_mask:0xf bank_mask:0xf
    s_nop 1
    v_max_f32_dpp v29, v29, v29 row_ror:2 row_mask:0xf bank_mask:0xf
    s_nop 1
    v_max_f32_dpp v29, v29, v29 row_ror:4 row_mask:0xf bank_mask:0xf
    s_nop 1
    v_max_f32_dpp v29, v29, v29 row_ror:8 row_mask:0xf bank_mask:0xf
    v_mov_b32 v30, v29
    s_nop 1
    v_permlane16_swap_b32 v29, v30
    s_nop 1
    v_max_f32 v29, v29, v30
    v_sub_f32 v23, v36, v29
    v_exp_f32 v23, v23
    s_nop 0
    v_mul_f32 v30, v23, v37
    s_nop 1
    v_add_f32_dpp v30, v30, v30 row_ror:1 row_mask:0xf bank_mask:0xf
    s_nop 1
    v_add_f32_dpp v30, v30, v30 row_ror:2 row_mask:0xf bank_mask:0xf
    s_nop 1
    v_add_f32_dpp v30, v30, v30 row_ror:4 row_mask:0xf bank_mask:0xf
    s_nop 1
    v_add_f32_dpp v30, v30, v30 row_ror:8 row_mask:0xf bank_mask:0xf
    v_mov_b32 v29, v30
    s_nop 1
    v_permlane16_swap_b32 v30, v29
    s_nop 1
    v_add_f32 v30, v30, v29
    v_rcp_f32 v30, v30
    s_nop 0
    v_mul_f32 v23, v23, v30
    s_waitcnt lgkmcnt(0)
    s_branch L_bs1
L_bs:
    s_ff1_i32_b32 s80, s65
    s_bitset0_b32 s65, s80
    s_max_i32 s49, s80, 0
    s_mul_i32 s48, s49, 800
    v_add_u32 v2, s48, v34
    ds_read_b128 v[56:59], v2 offset:7680
    s_ff1_i32_b32 s81, s65
    s_bitset0_b32 s65, s81
    s_max_i32 s49, s81, 0
    s_mul_i32 s48, s49, 800
    v_add_u32 v2, s48, v34
    ds_read_b128 v[60:63], v2 offset:7680
    s_ff1_i32_b32 s82, s65
    s_bitset0_b32 s65, s82
    s_max_i32 s49, s82, 0
    s_mul_i32 s48, s49, 800
    v_add_u32 v2, s48, v34
    ds_read_b128 v[64:67], v2 offset:7680
    s_ff1_i32_b32 s83, s65
    s_bitset0_b32 s65, s83
    s_max_i32 s49, s83, 0
    s_mul_i32 s48, s49, 800
    v_add_u32 v2, s48, v34
    ds_read_b128 v[68:71], v2 offset:7680
    s_ff1_i32_b32 s84, s65
    s_bitset0_b32 s65, s84
    s_max_i32 s49, s84, 0
    s_mul_i32 s48, s49, 800
    v_add_u32 v2, s48, v34
    ds_read_b128 v[224:227], v2 offset:7680
    s_ff1_i32_b32 s85, s65
    s_bitset0_b32 s65, s85
    s_max_i32 s49, s85, 0
    s_mul_i32 s48, s49, 800
    v_add_u32 v2, s48, v34
    ds_read_b128 v[228:231], v2 offset:7680
    s_ff1_i32_b32 s86, s65
    s_bitset0_b32 s65, s86
    s_max_i32 s49, s86, 0
    s_mul_i32 s48, s49, 800
    v_add_u32 v2, s48, v34
    ds_read_b128 v[232:235], v2 offset:7680
    s_ff1_i32_b32 s87, s65
    s_bitset0_b32 s65, s87
    s_max_i32 s49, s87, 0
    s_mul_i32 s48, s49, 800
    v_add_u32 v2, s48, v34
    ds_read_b128 v[236:239], v2 offset:7680
    s_ff1_i32_b32 s56, s65
    s_bitset0_b32 s65, s56
    s_max_i32 s49, s56, 0
    s_mul_i32 s48, s49, 800
    v_add_u32 v2, s48, v34
    ds_read_b128 v[240:243], v2 offset:7680
    s_ff1_i32_b32 s57, s65
    s_bitset0_b32 s65, s57
    s_max_i32 s49, s57, 0
    s_mul_i32 s48, s49, 800
    v_add_u32 v2, s48, v34
    ds_read_b128 v[244:247], v2 offset:7680
    s_ff1_i32_b32 s58, s65
    s_bitset0_b32 s65, s58
    s_max_i32 s49, s58, 0
    s_mul_i32 s48, s49, 800
    v_add_u32 v2, s48, v34
    ds_read_b128 v[248:251], v2 offset:7680
    s_ff1_i32_b32 s59, s65
    s_bitset0_b32 s65, s59
    s_max_i32 s49, s59, 0
    s_mul_i32 s48, s49, 800
    v_add_u32 v2, s48, v34
    ds_read_b128 v[252:255], v2 offset:7680
    s_waitcnt lgkmcnt(0)
L_bs1:
    s_cmp_lt_i32 s80, 0
    s_cbranch_scc1 L_bsd
    s_add_u32 s49, s80, 8
    v_readlane_b32 s48, v23, s49
    v_and_b32 v56, 0xffffff00, v56
    v_and_b32 v57, 0xffffff00, v57
    v_and_b32 v58, 0xffffff00, v58
    v_and_b32 v59, 0xffffff00, v59
    v_fmac_f32 v48, s48, v56
    v_fmac_f32 v49, s48, v57
    v_fmac_f32 v50, s48, v58
    v_fmac_f32 v51, s48, v59
    s_cmp_lt_i32 s81, 0
    s_cbranch_scc1 L_bsd
    s_add_u32 s49, s81, 8
    v_readlane_b32 s48, v23, s49
    v_and_b32 v60, 0xffffff00, v60
    v_and_b32 v61, 0xffffff00, v61
    v_and_b32 v62, 0xffffff00, v62
    v_and_b32 v63, 0xffffff00, v63
    v_fmac_f32 v48, s48, v60
    v_fmac_f32 v49, s48, v61
    v_fmac_f32 v50, s48, v62
    v_fmac_f32 v51, s48, v63
    s_cmp_lt_i32 s82, 0
    s_cbranch_scc1 L_bsd
    s_add_u32 s49, s82, 8
    v_readlane_b32 s48, v23, s49
    v_and_b32 v64, 0xffffff00, v64
    v_and_b32 v65, 0xffffff00, v65
    v_and_b32 v66, 0xffffff00, v66
    v_and_b32 v67, 0xffffff00, v67
    v_fmac_f32 v48, s48, v64
    v_fmac_f32 v49, s48, v65
    v_fmac_f32 v50, s48, v66
    v_fmac_f32 v51, s48, v67
    s_cmp_lt_i32 s83, 0
    s_cbranch_scc1 L_bsd
    s_add_u32 s49, s83, 8
    v_readlane_b32 s48, v23, s49
    v_and_b32 v68, 0xffffff00, v68
    v_and_b32 v69, 0xffffff00, v69
    v_and_b32 v70, 0xffffff00, v70
    v_and_b32 v71, 0xffffff00, v71
    v_fmac_f32 v48, s48, v68
    v_fmac_f32 v49, s48, v69
    v_fmac_f32 v50, s48, v70
    v_fmac_f32 v51, s48, v71
    s_cmp_lt_i32 s84, 0
    s_cbranch_scc1 L_bsd
    s_add_u32 s49, s84, 8
    v_readlane_b32 s48, v23, s49
    v_and_b32 v224, 0xffffff00, v224
    v_and_b32 v225, 0xffffff00, v225
    v_and_b32 v226, 0xffffff00, v226
    v_and_b32 v227, 0xffffff00, v227
    v_fmac_f32 v48, s48, v224
    v_fmac_f32 v49, s48, v225
    v_fmac_f32 v50, s48, v226
    v_fmac_f32 v51, s48, v227
    s_cmp_lt_i32 s85, 0
    s_cbranch_scc1 L_bsd
    s_add_u32 s49, s85, 8
    v_readlane_b32 s48, v23, s49
    v_and_b32 v228, 0xffffff00, v228
    v_and_b32 v229, 0xffffff00, v229
    v_and_b32 v230, 0xffffff00, v230
    v_and_b32 v231, 0xffffff00, v231
    v_fmac_f32 v48, s48, v228
    v_fmac_f32 v49, s48, v229
    v_fmac_f32 v50, s48, v230
    v_fmac_f32 v51, s48, v231
    s_cmp_lt_i32 s86, 0
    s_cbranch_scc1 L_bsd
    s_add_u32 s49, s86, 8
    v_readlane_b32 s48, v23, s49
    v_and_b32 v232, 0xffffff00, v232
    v_and_b32 v233, 0xffffff00, v233
    v_and_b32 v234, 0xffffff00, v234
    v_and_b32 v235, 0xffffff00, v235
    v_fmac_f32 v48, s48, v232
    v_fmac_f32 v49, s48, v233
    v_fmac_f32 v50, s48, v234
    v_fmac_f32 v51, s48, v235
    s_cmp_lt_i32 s87, 0
    s_cbranch_scc1 L_bsd
    s_add_u32 s49, s87, 8
    v_readlane_b32 s48, v23, s49
    v_and_b32 v236, 0xffffff00, v236
    v_and_b32 v237, 0xffffff00, v237
    v_and_b32 v238, 0xffffff00, v238
    v_and_b32 v239, 0xffffff00, v239
    v_fmac_f32 v48, s48, v236
    v_fmac_f32 v49, s48, v237
    v_fmac_f32 v50, s48, v238
    v_fmac_f32 v51, s48, v239
    s_cmp_lt_i32 s56, 0
    s_cbranch_scc1 L_bsd
    s_add_u32 s49, s56, 8
    v_readlane_b32 s48, v23, s49
    v_and_b32 v240, 0xffffff00, v240
    v_and_b32 v241, 0xffffff00, v241
    v_and_b32 v242, 0xffffff00, v242
    v_and_b32 v243, 0xffffff00, v243
    v_fmac_f32 v48, s48, v240
    v_fmac_f32 v49, s48, v241
    v_fmac_f32 v50, s48, v242
    v_fmac_f32 v51, s48, v243
    s_cmp_lt_i32 s57, 0
    s_cbranch_scc1 L_bsd
    s_add_u32 s49, s57, 8
    v_readlane_b32 s48, v23, s49
    v_and_b32 v244, 0xffffff00, v244
    v_and_b32 v245, 0xffffff00, v245
    v_and_b32 v246, 0xffffff00, v246
    v_and_b32 v247, 0xffffff00, v247
    v_fmac_f32 v48, s48, v244
    v_fmac_f32 v49, s48, v245
    v_fmac_f32 v50, s48, v246
    v_fmac_f32 v51, s48, v247
    s_cmp_lt_i32 s58, 0
    s_cbranch_scc1 L_bsd
    s_add_u32 s49, s58, 8
    v_readlane_b32 s48, v23, s49
    v_and_b32 v248, 0xffffff00, v248
    v_and_b32 v249, 0xffffff00, v249
    v_and_b32 v250, 0xffffff00, v250
    v_and_b32 v251, 0xffffff00, v251
    v_fmac_f32 v48, s48, v248
    v_fmac_f32 v49, s48, v249
    v_fmac_f32 v50, s48, v250
    v_fmac_f32 v51, s48, v251
    s_cmp_lt_i32 s59, 0
    s_cbranch_scc1 L_bsd
    s_add_u32 s49, s59, 8
    v_readlane_b32 s48, v23, s49
    v_and_b32 v252, 0xffffff00, v252
    v_and_b32 v253, 0xffffff00, v253
    v_and_b32 v254, 0xffffff00, v254
    v_and_b32 v255, 0xffffff00, v255
    v_fmac_f32 v48, s48, v252
    v_fmac_f32 v49, s48, v253
    v_fmac_f32 v50, s48, v254
    v_fmac_f32 v51, s48, v255
    s_cmp_lg_u32 s65, 0
    s_cbranch_scc1 L_bs
L_bsd:
    v_readlane_b32 s64, v23, 0
    v_readlane_b32 s65, v23, 1
    v_readlane_b32 s66, v23, 2
    v_readlane_b32 s67, v23, 3
    v_readlane_b32 s68, v23, 4
    v_readlane_b32 s69, v23, 5
    v_readlane_b32 s70, v23, 6
    v_readlane_b32 s71, v23, 7
L_now:
    s_waitcnt vmcnt(4)
    v_perm_b32 v73, v206, v200, s44
    v_perm_b32 v77, v206, v200, s45
    v_perm_b32 v81, v207, v201, s44
    v_perm_b32 v85, v207, v201, s45
    v_perm_b32 v89, v208, v202, s44
    v_perm_b32 v93, v208, v202, s45
    v_perm_b32 v97, v209, v203, s44
    v_perm_b32 v101, v209, v203, s45
    v_perm_b32 v105, v210, v204, s44
    v_perm_b32 v109, v210, v204, s45
    v_perm_b32 v113, v211, v205, s44
    v_perm_b32 v117, v211, v205, s45
    s_waitcnt vmcnt(0)
    v_perm_b32 v75, v218, v212, s44
    v_perm_b32 v79, v218, v212, s45
    v_perm_b32 v83, v219, v213, s44
    v_mfma_f32_16x16x32_bf16 v[128:131], v[72:75], v[44:47], v[128:131]
    v_perm_b32 v87, v219, v213, s45
    v_mfma_f32_16x16x32_bf16 v[132:135], v[76:79], v[44:47], v[132:135]
    v_perm_b32 v91, v220, v214, s44
    v_mfma_f32_16x16x32_bf16 v[136:139], v[80:83], v[44:47], v[136:139]
    v_perm_b32 v95, v220, v214, s45
    v_mfma_f32_16x16x32_bf16 v[140:143], v[84:87], v[44:47], v[140:143]
    v_perm_b32 v99, v221, v215, s44
    v_mfma_f32_16x16x32_bf16 v[144:147], v[88:91], v[44:47], v[144:147]
    v_perm_b32 v103, v221, v215, s45
    v_mfma_f32_16x16x32_bf16 v[148:151], v[92:95], v[44:47], v[148:151]
    v_perm_b32 v107, v222, v216, s44
    ds_write_b128 v5, v[128:131] offset:1280
    v_mfma_f32_16x16x32_bf16 v[152:155], v[96:99], v[44:47], v[152:155]
    v_perm_b32 v111, v222, v216, s45
    ds_write_b128 v5, v[132:135] offset:1344
    v_mfma_f32_16x16x32_bf16 v[156:159], v[100:103], v[44:47], v[156:159]
    v_perm_b32 v115, v223, v217, s44
    ds_write_b128 v5, v[136:139] offset:1408
    v_mfma_f32_16x16x32_bf16 v[160:163], v[104:107], v[44:47], v[160:163]
    v_perm_b32 v119, v223, v217, s45
    ds_write_b128 v5, v[140:143] offset:1472
    v_mfma_f32_16x16x32_bf16 v[164:167], v[108:111], v[44:47], v[164:167]
    ds_write_b128 v5, v[144:147] offset:1536
    v_mfma_f32_16x16x32_bf16 v[168:171], v[112:115], v[44:47], v[168:171]
    ds_write_b128 v5, v[148:151] offset:1600
    v_mfma_f32_16x16x32_bf16 v[172:175], v[116:119], v[44:47], v[172:175]
    ds_write_b128 v5, v[152:155] offset:1664
    ds_write_b128 v5, v[156:159] offset:1728
    ds_write_b128 v5, v[160:163] offset:1792
    s_nop 1
    ds_write_b128 v5, v[164:167] offset:1856
    s_nop 0
    ds_write_b128 v5, v[168:171] offset:1920
    s_nop 0
    ds_write_b128 v5, v[172:175] offset:1984
    s_waitcnt lgkmcnt(0)
    s_barrier
    s_cmp_lg_u32 s36, 3
    s_cbranch_scc1 L_stamp
    ds_read_b128 v[128:131], v34 offset:1280
    ds_read_b128 v[132:135], v34 offset:2080
    ds_read_b128 v[136:139], v34 offset:2880
    ds_read_b128 v[140:143], v34 offset:3680
    ds_read_b128 v[144:147], v34 offset:4480
    ds_read_b128 v[148:151], v34 offset:5280
    ds_read_b128 v[152:155], v34 offset:6080
    ds_read_b128 v[156:159], v34 offset:6880
    s_waitcnt lgkmcnt(7)
    v_fmac_f32 v48, s64, v128
    v_fmac_f32 v49, s64, v129
    v_fmac_f32 v50, s64, v130
    v_fmac_f32 v51, s64, v131
    s_waitcnt lgkmcnt(6)
    v_fmac_f32 v48, s65, v132
    v_fmac_f32 v49, s65, v133
    v_fmac_f32 v50, s65, v134
    v_fmac_f32 v51, s65, v135
    s_waitcnt lgkmcnt(5)
    v_fmac_f32 v48, s66, v136
    v_fmac_f32 v49, s66, v137
    v_fmac_f32 v50, s66, v138
    v_fmac_f32 v51, s66, v139
    s_waitcnt lgkmcnt(4)
    v_fmac_f32 v48, s67, v140
    v_fmac_f32 v49, s67, v141
    v_fmac_f32 v50, s67, v142
    v_fmac_f32 v51, s67, v143
    s_waitcnt lgkmcnt(3)
    v_fmac_f32 v48, s68, v144
    v_fmac_f32 v49, s68, v145
    v_fmac_f32 v50, s68, v146
    v_fmac_f32 v51, s68, v147
    s_waitcnt lgkmcnt(2)
    v_fmac_f32 v48, s69, v148
    v_fmac_f32 v49, s69, v149
    v_fmac_f32 v50, s69, v150
    v_fmac_f32 v51, s69, v151
    s_waitcnt lgkmcnt(1)
    v_fmac_f32 v48, s70, v152
    v_fmac_f32 v49, s70, v153
    v_fmac_f32 v50, s70, v154
    v_fmac_f32 v51, s70, v155
    s_waitcnt lgkmcnt(0)
    v_fmac_f32 v48, s71, v156
    v_fmac_f32 v49, s71, v157
    v_fmac_f32 v50, s71, v158
    v_fmac_f32 v51, s71, v159
    v_cvt_pk_bf16_f32 v36, v48, v49
    v_cvt_pk_bf16_f32 v37, v50, v51
    s_mov_b32 exec_hi, 0xffff
    buffer_store_short v36, v52, s[28:31], s47 offen
    buffer_store_short_d16_hi v36, v53, s[28:31], s47 offen
    buffer_store_short v37, v54, s[28:31], s47 offen
    buffer_store_short_d16_hi v37, v55, s[28:31], s47 offen
L_stamp:
    s_endpgm
L_slow0:
    s_mov_b32 s92, 0
L_slow:
    s_waitcnt vmcnt(0)
    v_add_u32 v2, s92, v1
    v_lshlrev_b32 v4, 2, v2
    ds_read_b32 v17, v4 offset:256
    v_add_u32 v2, s92, v1
    v_cmp_gt_u32 vcc, s62, v2
    v_and_b32 v4, 3, v1
    v_lshlrev_b32 v4, 3, v4
    s_mov_b32 s49, 196608
    v_mov_b32 v2, 226492416
    s_waitcnt lgkmcnt(0)
    v_lshrrev_b32 v18, 24, v17
    v_and_b32 v17, 0x7ff, v17
    v_cndmask_b32_e64 v18, 0, v18, vcc
    v_mul_lo_u32 v17, v17, s49
    v_lshlrev_b32 v18, v4, v18
    v_add_u32 v17, s37, v17
    v_cndmask_b32 v17, v2, v17, vcc
    v_or_b32_dpp v18, v18, v18 quad_perm:[1,0,3,2] row_mask:0xf bank_mask:0xf
    s_nop 1
    v_or_b32_dpp v18, v18, v18 quad_perm:[2,3,0,1] row_mask:0xf bank_mask:0xf
    s_nop 0
    s_mov_b32 s41, 0
    v_readlane_b32 s42, v18, s41
    v_readlane_b32 s56, v17, s41
    s_add_u32 s49, s41, 1
    v_readlane_b32 s57, v17, s49
    s_add_u32 s49, s41, 2
    v_readlane_b32 s58, v17, s49
    s_add_u32 s49, s41, 3
    v_readlane_b32 s59, v17, s49
    s_nop 0
    s_nop 4
    buffer_load_dwordx4 a[0:3], v5, s[20:23], s56 offen offset:0 nt
    buffer_load_dwordx4 a[4:7], v5, s[20:23], s56 offen offset:128 nt
    buffer_load_dwordx4 a[8:11], v5, s[20:23], s56 offen offset:256 nt
    buffer_load_dwordx4 a[12:15], v5, s[20:23], s57 offen offset:0 nt
    buffer_load_dwordx4 a[16:19], v5, s[20:23], s57 offen offset:128 nt
    buffer_load_dwordx4 a[20:23], v5, s[20:23], s57 offen offset:256 nt
    buffer_load_dwordx4 a[24:27], v5, s[20:23], s58 offen offset:0 nt
    buffer_load_dwordx4 a[28:31], v5, s[20:23], s58 offen offset:128 nt
    buffer_load_dwordx4 a[32:35], v5, s[20:23], s58 offen offset:256 nt
    buffer_load_dwordx4 a[36:39], v5, s[20:23], s59 offen offset:0 nt
    buffer_load_dwordx4 a[40:43], v5, s[20:23], s59 offen offset:128 nt
    buffer_load_dwordx4 a[44:47], v5, s[20:23], s59 offen offset:256 nt
    buffer_load_dwordx4 v[176:179], v6, s[24:27], s56 offen nt
    buffer_load_dwordx2 v[180:181], v7, s[24:27], s56 offen nt
    buffer_load_dwordx4 v[182:185], v8, s[24:27], s56 offen nt
    buffer_load_dwordx2 v[186:187], v9, s[24:27], s56 offen nt
    buffer_load_dwordx4 v[188:191], v6, s[24:27], s57 offen nt
    buffer_load_dwordx2 v[192:193], v7, s[24:27], s57 offen nt
    buffer_load_dwordx4 v[194:197], v8, s[24:27], s57 offen nt
    buffer_load_dwordx2 v[198:199], v9, s[24:27], s57 offen nt
    buffer_load_dwordx4 v[200:203], v6, s[24:27], s58 offen nt
    buffer_load_dwordx2 v[204:205], v7, s[24:27], s58 offen nt
    buffer_load_dwordx4 v[206:209], v8, s[24:27], s58 offen nt
    buffer_load_dwordx2 v[210:211], v9, s[24:27], s58 offen nt
    buffer_load_dwordx4 v[212:215], v6, s[24:27], s59 offen nt
    buffer_load_dwordx2 v[216:217], v7, s[24:27], s59 offen nt
    buffer_load_dwordx4 v[218:221], v8, s[24:27], s59 offen nt
    buffer_load_dwordx2 v[222:223], v9, s[24:27], s59 offen nt
    s_pack_ll_b32_b16 s80, s42, s42
    s_pack_hh_b32_b16 s84, s42, s42
    s_mov_b32 s81, s80
    s_mov_b32 s85, s84
    s_waitcnt vmcnt(16)
    v_mfma_f32_16x16x32_bf16 v[56:59], a[0:3], a[48:51], 0
    v_mfma_f32_16x16x32_bf16 v[56:59], a[4:7], a[52:55], v[56:59]
    v_mfma_f32_16x16x32_bf16 v[56:59], a[8:11], a[56:59], v[56:59]
    v_mfma_f32_16x16x32_bf16 v[64:67], a[12:15], a[48:51], 0
    v_mfma_f32_16x16x32_bf16 v[64:67], a[16:19], a[52:55], v[64:67]
    v_mfma_f32_16x16x32_bf16 v[64:67], a[20:23], a[56:59], v[64:67]
    v_mfma_f32_16x16x32_bf16 v[60:63], a[24:27], a[48:51], 0
    v_mfma_f32_16x16x32_bf16 v[60:63], a[28:31], a[52:55], v[60:63]
    v_mfma_f32_16x16x32_bf16 v[60:63], a[32:35], a[56:59], v[60:63]
    v_mfma_f32_16x16x32_bf16 v[68:71], a[36:39], a[48:51], 0
    v_mfma_f32_16x16x32_bf16 v[68:71], a[40:43], a[52:55], v[68:71]
    v_mfma_f32_16x16x32_bf16 v[68:71], a[44:47], a[56:59], v[68:71]
    s_nop 7
    v_add_f32_dpp v120, v57, v56 row_ror:8 row_mask:0xf bank_mask:0x3
    v_add_f32_dpp v120, v64, v65 row_ror:8 row_mask:0xf bank_mask:0xc
    v_add_f32_dpp v121, v59, v58 row_ror:8 row_mask:0xf bank_mask:0x3
    v_add_f32_dpp v121, v66, v67 row_ror:8 row_mask:0xf bank_mask:0xc
    v_add_f32_dpp v122, v61, v60 row_ror:8 row_mask:0xf bank_mask:0x3
    v_add_f32_dpp v122, v68, v69 row_ror:8 row_mask:0xf bank_mask:0xc
    v_add_f32_dpp v123, v63, v62 row_ror:8 row_mask:0xf bank_mask:0x3
    v_add_f32_dpp v123, v70, v71 row_ror:8 row_mask:0xf bank_mask:0xc
    v_mul_f32 v120, s46, v120
    v_mul_f32 v121, s46, v121
    v_mul_f32 v122, s46, v122
    v_mul_f32 v123, s46, v123
    v_cndmask_b32_e64 v120, v120, 0, s[60:61]
    v_cndmask_b32_e64 v121, v121, 0, s[60:61]
    v_cndmask_b32_e64 v122, v122, 0, s[60:61]
    v_cndmask_b32_e64 v123, v123, 0, s[60:61]
    v_cndmask_b32_e64 v120, v16, v120, s[80:81]
    v_cndmask_b32_e64 v121, v16, v121, s[80:81]
    v_cndmask_b32_e64 v122, v16, v122, s[84:85]
    v_cndmask_b32_e64 v123, v16, v123, s[84:85]
    v_max3_f32 v29, v120, v121, v19
    v_max3_f32 v29, v122, v123, v29
    v_mov_b32 v30, v29
    s_nop 1
    v_permlane16_swap_b32 v29, v30
    s_nop 1
    v_max_f32 v29, v29, v30
    v_mov_b32 v30, v29
    s_nop 1
    v_permlane32_swap_b32 v29, v30
    s_nop 1
    v_max_f32 v29, v29, v30
    v_sub_f32 v23, v19, v29
    v_mov_b32 v19, v29
    v_exp_f32 v23, v23
    s_nop 0
    v_mul_f32 v20, v20, v23
    v_mul_f32 v128, v128, v23
    v_mul_f32 v129, v129, v23
    v_mul_f32 v130, v130, v23
    v_mul_f32 v131, v131, v23
    v_mul_f32 v132, v132, v23
    v_mul_f32 v133, v133, v23
    v_mul_f32 v134, v134, v23
    v_mul_f32 v135, v135, v23
    v_mul_f32 v136, v136, v23
    v_mul_f32 v137, v137, v23
    v_mul_f32 v138, v138, v23
    v_mul_f32 v139, v139, v23
    v_mul_f32 v140, v140, v23
    v_mul_f32 v141, v141, v23
    v_mul_f32 v142, v142, v23
    v_mul_f32 v143, v143, v23
    v_mul_f32 v144, v144, v23
    v_mul_f32 v145, v145, v23
    v_mul_f32 v146, v146, v23
    v_mul_f32 v147, v147, v23
    v_mul_f32 v148, v148, v23
    v_mul_f32 v149, v149, v23
    v_mul_f32 v150, v150, v23
    v_mul_f32 v151, v151, v23
    v_mul_f32 v152, v152, v23
    v_mul_f32 v153, v153, v23
    v_mul_f32 v154, v154, v23
    v_mul_f32 v155, v155, v23
    v_mul_f32 v156, v156, v23
    v_mul_f32 v157, v157, v23
    v_mul_f32 v158, v158, v23
    v_mul_f32 v159, v159, v23
    v_mul_f32 v160, v160, v23
    v_mul_f32 v161, v161, v23
    v_mul_f32 v162, v162, v23
    v_mul_f32 v163, v163, v23
    v_mul_f32 v164, v164, v23
    v_mul_f32 v165, v165, v23
    v_mul_f32 v166, v166, v23
    v_mul_f32 v167, v167, v23
    v_mul_f32 v168, v168, v23
    v_mul_f32 v169, v169, v23
    v_mul_f32 v170, v170, v23
    v_mul_f32 v171, v171, v23
    v_mul_f32 v172, v172, v23
    v_mul_f32 v173, v173, v23
    v_mul_f32 v174, v174, v23
    v_mul_f32 v175, v175, v23
    v_sub_f32 v40, v120, v19
    v_sub_f32 v41, v121, v19
    v_sub_f32 v42, v122, v19
    v_sub_f32 v43, v123, v19
    v_exp_f32 v40, v40
    v_exp_f32 v41, v41
    v_exp_f32 v42, v42
    v_exp_f32 v43, v43
    s_nop 0
    v_cvt_pk_bf16_f32 v36, v40, v41
    v_cvt_pk_bf16_f32 v37, v42, v43
    v_add_f32 v2, v40, v41
    v_add_f32 v3, v42, v43
    v_and_b32 v44, v36, v14
    v_and_b32 v45, v37, v14
    v_and_b32 v46, v36, v15
    v_and_b32 v47, v37, v15
    v_add_f32 v2, v2, v3
    v_add_f32 v20, v20, v2
    s_waitcnt vmcnt(0)
    v_perm_b32 v72, v182, v176, s44
    v_perm_b32 v76, v182, v176, s45
    v_perm_b32 v80, v183, v177, s44
    v_perm_b32 v84, v183, v177, s45
    v_perm_b32 v88, v184, v178, s44
    v_perm_b32 v92, v184, v178, s45
    v_perm_b32 v96, v185, v179, s44
    v_perm_b32 v100, v185, v179, s45
    v_perm_b32 v104, v186, v180, s44
    v_perm_b32 v108, v186, v180, s45
    v_perm_b32 v112, v187, v181, s44
    v_perm_b32 v116, v187, v181, s45
    v_perm_b32 v74, v194, v188, s44
    v_perm_b32 v78, v194, v188, s45
    v_perm_b32 v82, v195, v189, s44
    v_perm_b32 v86, v195, v189, s45
    v_perm_b32 v90, v196, v190, s44
    v_perm_b32 v94, v196, v190, s45
    v_perm_b32 v98, v197, v191, s44
    v_perm_b32 v102, v197, v191, s45
    v_perm_b32 v106, v198, v192, s44
    v_perm_b32 v110, v198, v192, s45
    v_perm_b32 v114, v199, v193, s44
    v_perm_b32 v118, v199, v193, s45
    v_perm_b32 v73, v206, v200, s44
    v_perm_b32 v77, v206, v200, s45
    v_perm_b32 v81, v207, v201, s44
    v_perm_b32 v85, v207, v201, s45
    v_perm_b32 v89, v208, v202, s44
    v_perm_b32 v93, v208, v202, s45
    v_perm_b32 v97, v209, v203, s44
    v_perm_b32 v101, v209, v203, s45
    v_perm_b32 v105, v210, v204, s44
    v_perm_b32 v109, v210, v204, s45
    v_perm_b32 v113, v211, v205, s44
    v_perm_b32 v117, v211, v205, s45
    v_perm_b32 v75, v218, v212, s44
    v_perm_b32 v79, v218, v212, s45
    v_perm_b32 v83, v219, v213, s44
    v_perm_b32 v87, v219, v213, s45
    v_perm_b32 v91, v220, v214, s44
    v_perm_b32 v95, v220, v214, s45
    v_perm_b32 v99, v221, v215, s44
    v_perm_b32 v103, v221, v215, s45
    v_perm_b32 v107, v222, v216, s44
    v_perm_b32 v111, v222, v216, s45
    v_perm_b32 v115, v223, v217, s44
    v_perm_b32 v119, v223, v217, s45
    s_nop 1
    v_mfma_f32_16x16x32_bf16 v[128:131], v[72:75], v[44:47], v[128:131]
    v_mfma_f32_16x16x32_bf16 v[132:135], v[76:79], v[44:47], v[132:135]
    v_mfma_f32_16x16x32_bf16 v[136:139], v[80:83], v[44:47], v[136:139]
    v_mfma_f32_16x16x32_bf16 v[140:143], v[84:87], v[44:47], v[140:143]
    v_mfma_f32_16x16x32_bf16 v[144:147], v[88:91], v[44:47], v[144:147]
    v_mfma_f32_16x16x32_bf16 v[148:151], v[92:95], v[44:47], v[148:151]
    v_mfma_f32_16x16x32_bf16 v[152:155], v[96:99], v[44:47], v[152:155]
    v_mfma_f32_16x16x32_bf16 v[156:159], v[100:103], v[44:47], v[156:159]
    v_mfma_f32_16x16x32_bf16 v[160:163], v[104:107], v[44:47], v[160:163]
    v_mfma_f32_16x16x32_bf16 v[164:167], v[108:111], v[44:47], v[164:167]
    v_mfma_f32_16x16x32_bf16 v[168:171], v[112:115], v[44:47], v[168:171]
    v_mfma_f32_16x16x32_bf16 v[172:175], v[116:119], v[44:47], v[172:175]
    s_nop 7
    s_add_u32 s92, s92, 4
    s_cmp_lt_u32 s92, s62
    s_cbranch_scc1 L_slow
    buffer_load_dwordx4 a[0:3], v5, s[20:23], s94 offen offset:0 nt
    buffer_load_dwordx4 a[4:7], v5, s[20:23], s94 offen offset:128 nt
    buffer_load_dwordx4 a[8:11], v5, s[20:23], s94 offen offset:256 nt
    buffer_load_dwordx4 a[12:15], v5, s[20:23], s95 offen offset:0 nt
    buffer_load_dwordx4 a[16:19], v5, s[20:23], s95 offen offset:128 nt
    buffer_load_dwordx4 a[20:23], v5, s[20:23], s95 offen offset:256 nt
    buffer_load_dwordx4 a[24:27], v5, s[20:23], s96 offen offset:0 nt
    buffer_load_dwordx4 a[28:31], v5, s[20:23], s96 offen offset:128 nt
    buffer_load_dwordx4 a[32:35], v5, s[20:23], s96 offen offset:256 nt
    buffer_load_dwordx4 a[36:39], v5, s[20:23], s97 offen offset:0 nt
    buffer_load_dwordx4 a[40:43], v5, s[20:23], s97 offen offset:128 nt
    buffer_load_dwordx4 a[44:47], v5, s[20:23], s97 offen offset:256 nt
    s_waitcnt vmcnt(0)
    s_branch L_fast
L_miss:
    v_lshlrev_b32 v21, 4, v21
    v_cmp_gt_u32 vcc, s50, v21
    s_mov_b32 s49, 196608
    v_mov_b32 v22, 1152
    v_cndmask_b32 v30, v22, v30, vcc
    v_mul_lo_u32 v30, v30, s49
    v_add_u32 v30, s54, v30
    s_nop 0
    v_readlane_b32 s94, v30, 0
    v_readlane_b32 s95, v30, 1
    v_readlane_b32 s96, v30, 2
    v_readlane_b32 s97, v30, 3
    v_readlane_b32 s98, v30, 4
    v_readlane_b32 s99, v30, 5
    v_readlane_b32 s100, v30, 6
    v_readlane_b32 s101, v30, 7
    s_nop 4
    buffer_load_dwordx4 a[0:3], v5, s[20:23], s94 offen offset:0 nt
    buffer_load_dwordx4 a[4:7], v5, s[20:23], s94 offen offset:128 nt
    buffer_load_dwordx4 a[8:11], v5, s[20:23], s94 offen offset:256 nt
    buffer_load_dwordx4 a[12:15], v5, s[20:23], s95 offen offset:0 nt
    buffer_load_dwordx4 a[16:19], v5, s[20:23], s95 offen offset:128 nt
    buffer_load_dwordx4 a[20:23], v5, s[20:23], s95 offen offset:256 nt
    buffer_load_dwordx4 a[24:27], v5, s[20:23], s96 offen offset:0 nt
    buffer_load_dwordx4 a[28:31], v5, s[20:23], s96 offen offset:128 nt
    buffer_load_dwordx4 a[32:35], v5, s[20:23], s96 offen offset:256 nt
    buffer_load_dwordx4 a[36:39], v5, s[20:23], s97 offen offset:0 nt
    s_branch L_hit
L_end:
    s_endpgm

.section .rodata,"a"
.p2align 6
.amdhsa_kernel standalone__paged_block_table_kv_radixattention__sampling_kernel
  .amdhsa_next_free_vgpr 376
  .amdhsa_next_free_sgpr 102
  .amdhsa_accum_offset 256
  .amdhsa_group_segment_fixed_size 0
  .amdhsa_kernarg_size 64
  .amdhsa_user_sgpr_count 2
  .amdhsa_user_sgpr_kernarg_segment_ptr 1
  .amdhsa_system_sgpr_workgroup_id_x 1
.end_amdhsa_kernel
```
